```python
import torch

def _softmax(x, axis=-1):
    return torch.softmax(x, dim=axis)
def _gelu(x):
    return torch.nn.functional.gelu(x, approximate="tanh")
def _silu(x):
    return torch.nn.functional.silu(x)
def _sigmoid(x):
    return torch.sigmoid(x)
def _layernorm(x, axis=-1, eps=1e-5):
    m = x.mean(dim=axis, keepdim=True)
    v = x.var(dim=axis, keepdim=True, unbiased=False)
    return (x - m) / torch.sqrt(v + eps)
def _scatter_add(tgt, idx, src, axis=0):
    return tgt.clone().index_add_(axis, idx, src)
def _segment_sum(src, seg, n):
    out = torch.zeros((n,) + src.shape[1:], dtype=src.dtype)
    return out.index_add_(0, seg, src)
def _pad(x, pw):
    flat = tuple(v for pair in reversed(pw) for v in pair)
    return torch.nn.functional.pad(x, flat)

kernel_name = 'recurrent_scan__gqa_block_cached__geglu_ffn__decode'

def setup_inputs():

    _w = (lambda a: (lambda t: t.to(torch.bfloat16) if t.is_floating_point() else t)(torch.as_tensor(a)))
    def _A_setup():
        B, Sq, D = 1, 1, 448
        Hq, Hkv, Sk, Dh = 16, 8, 16384, 256
        assert Hq % Hkv == 0, (Hq, Hkv)
        return {
            "x": _w((lambda *s: torch.randn(*s, dtype=torch.bfloat16) * 0.05)(B, Sq, D)),
            "k_cache": _w((lambda *s: torch.randn(*s, dtype=torch.bfloat16) * 0.8)(B, Hkv, Sk, Dh)),
            "v_cache": _w((lambda *s: torch.randn(*s, dtype=torch.bfloat16) * 0.8)(B, Hkv, Sk, Dh)),
            "wq": _w((lambda *s: torch.randn(*s, dtype=torch.bfloat16) * 0.8)(D, Hq * Dh) * (D ** -0.5)),
            "wo": _w((lambda *s: torch.randn(*s, dtype=torch.bfloat16) * 0.8)(Hq * Dh, D) * ((Hq * Dh) ** -0.5)),
        }
    _A_in = _A_setup()

    def _B_setup():
        B, S, D, F = 1, 1, 448, 1792
        return {
            "x": _w((lambda *s: torch.randn(*s, dtype=torch.bfloat16) * 0.05)(B, S, D)),
            "w_gate": _w((lambda *s: torch.randn(*s, dtype=torch.bfloat16) * 0.2)(D, F)),
            "w_up": _w((lambda *s: torch.randn(*s, dtype=torch.bfloat16) * 0.2)(D, F)),
            "w_down": _w((lambda *s: torch.randn(*s, dtype=torch.bfloat16) * 0.2)(F, D)),
        }
    _B_in = _B_setup()

    return {
        "A_x": _A_in["x"],
        "A_k_cache": _A_in["k_cache"],
        "A_v_cache": _A_in["v_cache"],
        "A_wq": _A_in["wq"],
        "A_wo": _A_in["wo"],
        "B_x": _B_in["x"],
        "B_w_gate": _B_in["w_gate"],
        "B_w_up": _B_in["w_up"],
        "B_w_down": _B_in["w_down"],
    }

def reference(A_x, A_k_cache, A_v_cache, A_wq, A_wo, B_x, B_w_gate, B_w_up, B_w_down):
    def _A_ref(x, k_cache, v_cache, wq, wo):
        B, Sq, D = x.shape
        Hq, Dh = 16, 256
        Hkv = k_cache.shape[1]
        rep = Hq // Hkv
        q = (lambda x, *d: x.permute(*d))((x @ wq).reshape(B, Sq, Hq, Dh), 0, 2, 1, 3)
        k = (lambda x, n, axis: torch.repeat_interleave(x, n, dim=axis))(k_cache, rep, axis=1)
        v = (lambda x, n, axis: torch.repeat_interleave(x, n, dim=axis))(v_cache, rep, axis=1)
        scores = torch.einsum("bhqd,bhkd->bhqk", q, k) * (Dh ** -0.5)
        p = _softmax(scores, axis=-1)
        o = torch.einsum("bhqk,bhkd->bhqd", p, v)
        return (lambda x, *d: x.permute(*d))(o, 0, 2, 1, 3).reshape(B, Sq, Hq * Dh) @ wo

    def _B_ref(x, w_gate, w_up, w_down):
        return (_gelu(x @ w_gate) * (x @ w_up)) @ w_down

    x = A_x
    xn = _layernorm(x, axis=-1)
    s = _A_ref(xn, A_k_cache, A_v_cache, A_wq, A_wo)
    g = _silu(_B_ref(xn, B_w_gate, B_w_up, B_w_down))
    return x + s * g
```

```asm
; @launch grid=(256,1,1) block=(512,1,1) lds=16384
.amdgcn_target "amdgcn-amd-amdhsa--gfx950"
.text
.globl recurrent_scan__gqa_block_cached__geglu_ffn__decode_kernel
.p2align 8
.type recurrent_scan__gqa_block_cached__geglu_ffn__decode_kernel,@function
recurrent_scan__gqa_block_cached__geglu_ffn__decode_kernel:
    s_cmp_ge_u32 s2, 256
    s_cbranch_scc1 L_end
    s_load_dwordx8 s[8:15], s[0:1], 0
    s_load_dwordx8 s[16:23], s[0:1], 32
    s_load_dwordx8 s[24:31], s[0:1], 64
    v_lshrrev_b32 v2, 6, v0
    v_and_b32 v1, 63, v0
    v_readfirstlane_b32 s3, v2
    s_lshr_b32 s4, s2, 5
    s_and_b32 s5, s2, 31
    s_cmp_lg_u32 s3, 7
    s_cbranch_scc1 L_b0
    v_lshlrev_b32 v8, 2, v1
    v_mov_b32 v9, 0xfffffffe
    v_mov_b32 v10, 0
    s_mov_b64 exec, 0xff
    ds_write_b32 v8, v10 offset:10496
    s_mov_b64 exec, 15
    ds_write_b32 v8, v10 offset:11776
    s_mov_b64 exec, -1
    ds_write_b32 v8, v9 offset:11264
    ds_write_b32 v8, v9 offset:11520
    s_waitcnt lgkmcnt(0)
    s_barrier
    s_load_dword s6, s[30:31], 0
    s_branch L_h3
L_b0:
    s_cmp_ge_u32 s3, 4
    s_cbranch_scc1 L_helpers
    v_bfe_u32 v8, v1, 2, 2
    v_lshlrev_b32 v8, 9, v8
    v_lshrrev_b32 v9, 4, v1
    v_lshlrev_b32 v10, 6, v9
    v_and_b32 v11, 3, v1
    v_lshlrev_b32 v11, 4, v11
    v_add3_u32 v2, v8, v10, v11
    v_lshlrev_b32 v9, 9, v9
    v_and_b32 v10, 15, v1
    v_lshlrev_b32 v10, 4, v10
    v_add_u32 v3, v9, v10
    s_lshl_b32 s55, s3, 11
    v_add_u32 v2, s55, v2
    v_add_u32 v3, s55, v3
    v_mov_b32 v0, 0
    s_lshl_b32 s44, s5, 18
    s_lshl_b32 s55, s4, 23
    s_waitcnt lgkmcnt(0)
    s_add_u32 s32, s10, s55
    s_addc_u32 s33, s11, 0
    s_mov_b32 s34, 0x800000
    s_mov_b32 s35, 0x20000
    s_add_u32 s36, s12, s55
    s_addc_u32 s37, s13, 0
    s_mov_b32 s38, 0x800000
    s_mov_b32 s39, 0x20000
    buffer_load_dwordx4 v[40:43], v2, s[32:35], s44 offen offset:0 nt
    buffer_load_dwordx4 v[44:47], v2, s[32:35], s44 offen offset:256 nt
    buffer_load_dwordx4 v[48:51], v3, s[36:39], s44 offen offset:0 nt
    buffer_load_dwordx4 v[52:55], v3, s[36:39], s44 offen offset:256 nt
    s_add_u32 s44, s44, 8192
    buffer_load_dwordx4 v[56:59], v2, s[32:35], s44 offen offset:0 nt
    buffer_load_dwordx4 v[60:63], v2, s[32:35], s44 offen offset:256 nt
    buffer_load_dwordx4 v[64:67], v3, s[36:39], s44 offen offset:0 nt
    buffer_load_dwordx4 v[68:71], v3, s[36:39], s44 offen offset:256 nt
    s_barrier
    s_waitcnt vmcnt(7)
    s_add_u32 s44, s44, 8192
    buffer_load_dwordx4 v[72:75], v2, s[32:35], s44 offen offset:0 nt
    s_waitcnt vmcnt(7)
    buffer_load_dwordx4 v[76:79], v2, s[32:35], s44 offen offset:256 nt
    s_waitcnt vmcnt(7)
    buffer_load_dwordx4 v[80:83], v3, s[36:39], s44 offen offset:0 nt
    s_waitcnt vmcnt(7)
    buffer_load_dwordx4 v[84:87], v3, s[36:39], s44 offen offset:256 nt
    s_waitcnt vmcnt(7)
    s_add_u32 s44, s44, 8192
    buffer_load_dwordx4 v[88:91], v2, s[32:35], s44 offen offset:0 nt
    s_waitcnt vmcnt(7)
    buffer_load_dwordx4 v[92:95], v2, s[32:35], s44 offen offset:256 nt
    s_waitcnt vmcnt(7)
    buffer_load_dwordx4 v[96:99], v3, s[36:39], s44 offen offset:0 nt
    s_waitcnt vmcnt(7)
    buffer_load_dwordx4 v[100:103], v3, s[36:39], s44 offen offset:256 nt
    s_load_dword s6, s[30:31], 0
    v_and_b32 v37, 1, v1
    v_lshlrev_b32 v37, 4, v37
    v_mov_b32 v38, 0xffff
    v_lshlrev_b32 v37, v37, v38
    v_bfe_u32 v38, v1, 1, 2
    v_cmp_eq_u32 vcc, 0, v38
    s_nop 1
    v_cndmask_b32 v8, 0, v37, vcc
    v_cmp_eq_u32 vcc, 1, v38
    s_nop 1
    v_cndmask_b32 v9, 0, v37, vcc
    v_cmp_eq_u32 vcc, 2, v38
    s_nop 1
    v_cndmask_b32 v10, 0, v37, vcc
    v_cmp_eq_u32 vcc, 3, v38
    s_nop 1
    v_cndmask_b32 v11, 0, v37, vcc
    v_mov_b32 v6, 0x3db8aa3b
    v_mov_b32 v4, 0
    v_mov_b32 v5, 0
    v_mov_b32 v28, 0
    v_mov_b32 v29, 0
    v_mov_b32 v30, 0
    v_mov_b32 v31, 0
    v_mov_b32 v32, 0
    v_mov_b32 v33, 0
    v_mov_b32 v34, 0
    v_mov_b32 v35, 0
    v_lshrrev_b32 v248, 3, v1
    v_lshlrev_b32 v248, 4, v248
    s_lshl_b32 s54, s3, 2
    v_add_u32 v248, s54, v248
    v_lshrrev_b32 v249, 5, v1
    v_lshlrev_b32 v249, 10, v249
    v_and_b32 v37, 15, v1
    v_lshlrev_b32 v37, 5, v37
    v_add_u32 v249, v249, v37
    v_bfe_u32 v37, v1, 4, 1
    v_lshlrev_b32 v37, 4, v37
    s_lshl_b32 s54, s3, 11
    v_add3_u32 v249, v249, v37, s54
    s_lshr_b32 s54, s3, 1
    s_and_b32 s55, s3, 1
    s_lshl_b32 s55, s55, 6
    v_add_u32 v37, s55, v1
    s_lshl_b32 s55, s54, 10
    v_lshlrev_b32 v250, 3, v37
    v_add_u32 v250, s55, v250
    s_lshl_b32 s55, s54, 4
    v_mov_b32 v251, s55
    s_mov_b32 s40, s30
    s_mov_b32 s41, s31
    s_mov_b32 s42, 4194304
    s_mov_b32 s43, 0x20000
    s_lshl_b32 s55, s4, 5
    s_lshl_b32 s56, s54, 4
    s_add_u32 s55, s55, s56
    s_lshl_b32 s55, s55, 12
    s_lshl_b32 s56, s5, 7
    s_add_u32 s55, s55, s56
    s_add_u32 s55, s55, 1572864
    v_lshrrev_b32 v252, 3, v37
    v_lshlrev_b32 v252, 12, v252
    v_and_b32 v37, 7, v37
    v_lshlrev_b32 v37, 4, v37
    v_add3_u32 v252, v252, v37, s55
    s_waitcnt vmcnt(7)
    s_add_u32 s44, s44, 8192
    buffer_load_dwordx4 v[104:107], v2, s[32:35], s44 offen offset:0 nt
    s_waitcnt vmcnt(7)
    buffer_load_dwordx4 v[108:111], v2, s[32:35], s44 offen offset:256 nt
    s_waitcnt vmcnt(7)
    buffer_load_dwordx4 v[112:115], v3, s[36:39], s44 offen offset:0 nt
    s_waitcnt vmcnt(7)
    buffer_load_dwordx4 v[116:119], v3, s[36:39], s44 offen offset:256 nt
    s_waitcnt vmcnt(7)
    s_add_u32 s44, s44, 8192
    buffer_load_dwordx4 v[120:123], v2, s[32:35], s44 offen offset:0 nt
    s_waitcnt vmcnt(7)
    buffer_load_dwordx4 v[124:127], v2, s[32:35], s44 offen offset:256 nt
    s_waitcnt vmcnt(7)
    buffer_load_dwordx4 v[128:131], v3, s[36:39], s44 offen offset:0 nt
    s_waitcnt vmcnt(7)
    buffer_load_dwordx4 v[132:135], v3, s[36:39], s44 offen offset:256 nt
    s_waitcnt vmcnt(7)
    s_add_u32 s44, s44, 8192
    buffer_load_dwordx4 v[136:139], v2, s[32:35], s44 offen offset:0 nt
    s_waitcnt vmcnt(7)
    buffer_load_dwordx4 v[140:143], v2, s[32:35], s44 offen offset:256 nt
    s_waitcnt vmcnt(7)
    buffer_load_dwordx4 v[144:147], v3, s[36:39], s44 offen offset:0 nt
    s_waitcnt vmcnt(7)
    buffer_load_dwordx4 v[148:151], v3, s[36:39], s44 offen offset:256 nt
    s_waitcnt vmcnt(7)
    s_add_u32 s44, s44, 8192
    buffer_load_dwordx4 v[152:155], v2, s[32:35], s44 offen offset:0 nt
    s_waitcnt vmcnt(7)
    buffer_load_dwordx4 v[156:159], v2, s[32:35], s44 offen offset:256 nt
    s_waitcnt vmcnt(7)
    buffer_load_dwordx4 v[160:163], v3, s[36:39], s44 offen offset:0 nt
    s_waitcnt vmcnt(7)
    buffer_load_dwordx4 v[164:167], v3, s[36:39], s44 offen offset:256 nt
    s_waitcnt vmcnt(7)
    s_add_u32 s44, s44, 8192
    buffer_load_dwordx4 v[168:171], v2, s[32:35], s44 offen offset:0 nt
    s_waitcnt vmcnt(7)
    buffer_load_dwordx4 v[172:175], v2, s[32:35], s44 offen offset:256 nt
    s_waitcnt vmcnt(7)
    buffer_load_dwordx4 v[176:179], v3, s[36:39], s44 offen offset:0 nt
    s_waitcnt vmcnt(7)
    buffer_load_dwordx4 v[180:183], v3, s[36:39], s44 offen offset:256 nt
    s_waitcnt vmcnt(7)
    s_add_u32 s44, s44, 8192
    buffer_load_dwordx4 v[184:187], v2, s[32:35], s44 offen offset:0 nt
    s_waitcnt vmcnt(7)
    buffer_load_dwordx4 v[188:191], v2, s[32:35], s44 offen offset:256 nt
    s_waitcnt vmcnt(7)
    buffer_load_dwordx4 v[192:195], v3, s[36:39], s44 offen offset:0 nt
    s_waitcnt vmcnt(7)
    buffer_load_dwordx4 v[196:199], v3, s[36:39], s44 offen offset:256 nt
    s_waitcnt vmcnt(7)
    s_add_u32 s44, s44, 8192
    buffer_load_dwordx4 v[200:203], v2, s[32:35], s44 offen offset:0 nt
    s_waitcnt vmcnt(7)
    buffer_load_dwordx4 v[204:207], v2, s[32:35], s44 offen offset:256 nt
    s_waitcnt vmcnt(7)
    buffer_load_dwordx4 v[208:211], v3, s[36:39], s44 offen offset:0 nt
    s_waitcnt vmcnt(7)
    buffer_load_dwordx4 v[212:215], v3, s[36:39], s44 offen offset:256 nt
    s_waitcnt vmcnt(7)
    s_add_u32 s44, s44, 8192
    buffer_load_dwordx4 v[216:219], v2, s[32:35], s44 offen offset:0 nt
    s_waitcnt vmcnt(7)
    buffer_load_dwordx4 v[220:223], v2, s[32:35], s44 offen offset:256 nt
    s_waitcnt vmcnt(7)
    buffer_load_dwordx4 v[224:227], v3, s[36:39], s44 offen offset:0 nt
    s_waitcnt vmcnt(7)
    buffer_load_dwordx4 v[228:231], v3, s[36:39], s44 offen offset:256 nt
    s_waitcnt vmcnt(7)
    s_add_u32 s44, s44, 8192
    buffer_load_dwordx4 v[232:235], v2, s[32:35], s44 offen offset:0 nt
    s_waitcnt vmcnt(7)
    buffer_load_dwordx4 v[236:239], v2, s[32:35], s44 offen offset:256 nt
    s_waitcnt vmcnt(7)
    buffer_load_dwordx4 v[240:243], v3, s[36:39], s44 offen offset:0 nt
    s_waitcnt vmcnt(7)
    buffer_load_dwordx4 v[244:247], v3, s[36:39], s44 offen offset:256 nt
    s_waitcnt lgkmcnt(0)
    s_mul_i32 s6, s6, 0x9E3779B1
    s_add_u32 s6, s6, 0x7F4A7C15
    s_mov_b32 s62, 200000
    v_mov_b32 v39, 0
    s_nop 1
L_qw:
    ds_read_b128 v[20:23], v39 offset:10512
    s_waitcnt lgkmcnt(0)
    v_and_b32 v37, v20, v21
    v_and_b32 v38, v22, v23
    v_and_b32 v37, v37, v38
    v_cmp_eq_u32 vcc, 0, v37
    s_cbranch_vccz L_qw_ok
    s_sleep 1
    s_sub_u32 s62, s62, 1
    s_cmp_lg_u32 s62, 0
    s_cbranch_scc1 L_qw
L_qw_ok:
    v_bfe_u32 v37, v1, 3, 1
    v_lshlrev_b32 v37, 9, v37
    v_lshrrev_b32 v38, 4, v1
    v_lshlrev_b32 v38, 6, v38
    v_add_u32 v37, v37, v38
    v_and_b32 v38, 3, v1
    v_lshlrev_b32 v38, 4, v38
    v_add_u32 v37, v37, v38
    ds_read_b128 v[12:15], v37 offset:0
    ds_read_b128 v[16:19], v37 offset:256
    s_waitcnt lgkmcnt(0)
    v_mfma_f32_16x16x32_bf16 v[20:23], v[40:43], v[12:15], 0
    v_mfma_f32_16x16x32_bf16 v[20:23], v[44:47], v[16:19], v[20:23]
    v_mov_b32 v7, v4
    v_mov_b32 v37, 0
    s_nop 5
    v_fmac_f32_dpp v7, v20, v6 quad_perm:[0,0,0,0] row_mask:0xf bank_mask:0xf
    v_fmac_f32_dpp v37, v21, v6 quad_perm:[1,1,1,1] row_mask:0xf bank_mask:0xf
    s_nop 0
    v_fmac_f32_dpp v7, v22, v6 quad_perm:[2,2,2,2] row_mask:0xf bank_mask:0xf
    v_fmac_f32_dpp v37, v23, v6 quad_perm:[3,3,3,3] row_mask:0xf bank_mask:0xf
    v_add_f32 v7, v7, v37
    v_mov_b32 v37, v7
    v_mov_b32 v38, v37
    s_nop 1
    v_permlane16_swap_b32 v37, v38
    s_nop 0
    v_max_f32 v37, v37, v38
    v_mov_b32 v38, v37
    s_nop 1
    v_permlane32_swap_b32 v37, v38
    s_nop 0
    v_max_f32 v37, v37, v38
    v_sub_f32 v4, 0, v37
    v_sub_f32 v7, v7, v37
    v_exp_f32 v7, v7
    s_nop 0
    v_cvt_pk_bf16_f32 v36, v7, v7
    v_add_f32 v5, v5, v7
    v_and_b32 v24, v36, v8
    v_and_b32 v25, v36, v9
    v_and_b32 v26, v36, v10
    v_and_b32 v27, v36, v11
    s_nop 1
    v_mfma_f32_16x16x32_bf16 v[28:31], v[24:27], v[48:51], v[28:31]
    v_mfma_f32_16x16x32_bf16 v[32:35], v[24:27], v[52:55], v[32:35]
    s_waitcnt vmcnt(7)
    s_add_u32 s44, s44, 8192
    buffer_load_dwordx4 v[40:43], v2, s[32:35], s44 offen offset:0 nt
    v_mfma_f32_16x16x32_bf16 v[20:23], v[56:59], v[12:15], 0
    v_mfma_f32_16x16x32_bf16 v[20:23], v[60:63], v[16:19], v[20:23]
    v_mov_b32 v7, v4
    v_mov_b32 v37, 0
    s_nop 5
    v_fmac_f32_dpp v7, v20, v6 quad_perm:[0,0,0,0] row_mask:0xf bank_mask:0xf
    v_fmac_f32_dpp v37, v21, v6 quad_perm:[1,1,1,1] row_mask:0xf bank_mask:0xf
    s_nop 0
    v_fmac_f32_dpp v7, v22, v6 quad_perm:[2,2,2,2] row_mask:0xf bank_mask:0xf
    v_fmac_f32_dpp v37, v23, v6 quad_perm:[3,3,3,3] row_mask:0xf bank_mask:0xf
    v_add_f32 v7, v7, v37
    v_cmp_lt_f32 vcc, 0x41000000, v7
    s_cbranch_vccnz L_stub1
L_res1:
    v_exp_f32 v7, v7
    s_nop 0
    v_cvt_pk_bf16_f32 v36, v7, v7
    v_add_f32 v5, v5, v7
    v_and_b32 v24, v36, v8
    v_and_b32 v25, v36, v9
    v_and_b32 v26, v36, v10
    v_and_b32 v27, v36, v11
    s_nop 1
    v_mfma_f32_16x16x32_bf16 v[28:31], v[24:27], v[64:67], v[28:31]
    v_mfma_f32_16x16x32_bf16 v[32:35], v[24:27], v[68:71], v[32:35]
    s_waitcnt vmcnt(7)
    buffer_load_dwordx4 v[44:47], v2, s[32:35], s44 offen offset:256 nt
    v_mfma_f32_16x16x32_bf16 v[20:23], v[72:75], v[12:15], 0
    v_mfma_f32_16x16x32_bf16 v[20:23], v[76:79], v[16:19], v[20:23]
    v_mov_b32 v7, v4
    v_mov_b32 v37, 0
    s_nop 5
    v_fmac_f32_dpp v7, v20, v6 quad_perm:[0,0,0,0] row_mask:0xf bank_mask:0xf
    v_fmac_f32_dpp v37, v21, v6 quad_perm:[1,1,1,1] row_mask:0xf bank_mask:0xf
    s_nop 0
    v_fmac_f32_dpp v7, v22, v6 quad_perm:[2,2,2,2] row_mask:0xf bank_mask:0xf
    v_fmac_f32_dpp v37, v23, v6 quad_perm:[3,3,3,3] row_mask:0xf bank_mask:0xf
    v_add_f32 v7, v7, v37
    v_cmp_lt_f32 vcc, 0x41000000, v7
    s_cbranch_vccnz L_stub2
L_res2:
    v_exp_f32 v7, v7
    s_nop 0
    v_cvt_pk_bf16_f32 v36, v7, v7
    v_add_f32 v5, v5, v7
    v_and_b32 v24, v36, v8
    v_and_b32 v25, v36, v9
    v_and_b32 v26, v36, v10
    v_and_b32 v27, v36, v11
    s_nop 1
    v_mfma_f32_16x16x32_bf16 v[28:31], v[24:27], v[80:83], v[28:31]
    v_mfma_f32_16x16x32_bf16 v[32:35], v[24:27], v[84:87], v[32:35]
    s_waitcnt vmcnt(7)
    buffer_load_dwordx4 v[48:51], v3, s[36:39], s44 offen offset:0 nt
    v_mfma_f32_16x16x32_bf16 v[20:23], v[88:91], v[12:15], 0
    v_mfma_f32_16x16x32_bf16 v[20:23], v[92:95], v[16:19], v[20:23]
    v_mov_b32 v7, v4
    v_mov_b32 v37, 0
    s_nop 5
    v_fmac_f32_dpp v7, v20, v6 quad_perm:[0,0,0,0] row_mask:0xf bank_mask:0xf
    v_fmac_f32_dpp v37, v21, v6 quad_perm:[1,1,1,1] row_mask:0xf bank_mask:0xf
    s_nop 0
    v_fmac_f32_dpp v7, v22, v6 quad_perm:[2,2,2,2] row_mask:0xf bank_mask:0xf
    v_fmac_f32_dpp v37, v23, v6 quad_perm:[3,3,3,3] row_mask:0xf bank_mask:0xf
    v_add_f32 v7, v7, v37
    v_cmp_lt_f32 vcc, 0x41000000, v7
    s_cbranch_vccnz L_stub3
L_res3:
    v_exp_f32 v7, v7
    s_nop 0
    v_cvt_pk_bf16_f32 v36, v7, v7
    v_add_f32 v5, v5, v7
    v_and_b32 v24, v36, v8
    v_and_b32 v25, v36, v9
    v_and_b32 v26, v36, v10
    v_and_b32 v27, v36, v11
    s_nop 1
    v_mfma_f32_16x16x32_bf16 v[28:31], v[24:27], v[96:99], v[28:31]
    v_mfma_f32_16x16x32_bf16 v[32:35], v[24:27], v[100:103], v[32:35]
    s_waitcnt vmcnt(7)
    buffer_load_dwordx4 v[52:55], v3, s[36:39], s44 offen offset:256 nt
    v_mfma_f32_16x16x32_bf16 v[20:23], v[104:107], v[12:15], 0
    v_mfma_f32_16x16x32_bf16 v[20:23], v[108:111], v[16:19], v[20:23]
    v_mov_b32 v7, v4
    v_mov_b32 v37, 0
    s_nop 5
    v_fmac_f32_dpp v7, v20, v6 quad_perm:[0,0,0,0] row_mask:0xf bank_mask:0xf
    v_fmac_f32_dpp v37, v21, v6 quad_perm:[1,1,1,1] row_mask:0xf bank_mask:0xf
    s_nop 0
    v_fmac_f32_dpp v7, v22, v6 quad_perm:[2,2,2,2] row_mask:0xf bank_mask:0xf
    v_fmac_f32_dpp v37, v23, v6 quad_perm:[3,3,3,3] row_mask:0xf bank_mask:0xf
    v_add_f32 v7, v7, v37
    v_cmp_lt_f32 vcc, 0x41000000, v7
    s_cbranch_vccnz L_stub4
L_res4:
    v_exp_f32 v7, v7
    s_nop 0
    v_cvt_pk_bf16_f32 v36, v7, v7
    v_add_f32 v5, v5, v7
    v_and_b32 v24, v36, v8
    v_and_b32 v25, v36, v9
    v_and_b32 v26, v36, v10
    v_and_b32 v27, v36, v11
    s_nop 1
    v_mfma_f32_16x16x32_bf16 v[28:31], v[24:27], v[112:115], v[28:31]
    v_mfma_f32_16x16x32_bf16 v[32:35], v[24:27], v[116:119], v[32:35]
    s_waitcnt vmcnt(7)
    s_add_u32 s44, s44, 8192
    buffer_load_dwordx4 v[56:59], v2, s[32:35], s44 offen offset:0 nt
    v_mfma_f32_16x16x32_bf16 v[20:23], v[120:123], v[12:15], 0
    v_mfma_f32_16x16x32_bf16 v[20:23], v[124:127], v[16:19], v[20:23]
    v_mov_b32 v7, v4
    v_mov_b32 v37, 0
    s_nop 5
    v_fmac_f32_dpp v7, v20, v6 quad_perm:[0,0,0,0] row_mask:0xf bank_mask:0xf
    v_fmac_f32_dpp v37, v21, v6 quad_perm:[1,1,1,1] row_mask:0xf bank_mask:0xf
    s_nop 0
    v_fmac_f32_dpp v7, v22, v6 quad_perm:[2,2,2,2] row_mask:0xf bank_mask:0xf
    v_fmac_f32_dpp v37, v23, v6 quad_perm:[3,3,3,3] row_mask:0xf bank_mask:0xf
    v_add_f32 v7, v7, v37
    v_cmp_lt_f32 vcc, 0x41000000, v7
    s_cbranch_vccnz L_stub5
L_res5:
    v_exp_f32 v7, v7
    s_nop 0
    v_cvt_pk_bf16_f32 v36, v7, v7
    v_add_f32 v5, v5, v7
    v_and_b32 v24, v36, v8
    v_and_b32 v25, v36, v9
    v_and_b32 v26, v36, v10
    v_and_b32 v27, v36, v11
    s_nop 1
    v_mfma_f32_16x16x32_bf16 v[28:31], v[24:27], v[128:131], v[28:31]
    v_mfma_f32_16x16x32_bf16 v[32:35], v[24:27], v[132:135], v[32:35]
    s_waitcnt vmcnt(7)
    buffer_load_dwordx4 v[60:63], v2, s[32:35], s44 offen offset:256 nt
    v_mfma_f32_16x16x32_bf16 v[20:23], v[136:139], v[12:15], 0
    v_mfma_f32_16x16x32_bf16 v[20:23], v[140:143], v[16:19], v[20:23]
    v_mov_b32 v7, v4
    v_mov_b32 v37, 0
    s_nop 5
    v_fmac_f32_dpp v7, v20, v6 quad_perm:[0,0,0,0] row_mask:0xf bank_mask:0xf
    v_fmac_f32_dpp v37, v21, v6 quad_perm:[1,1,1,1] row_mask:0xf bank_mask:0xf
    s_nop 0
    v_fmac_f32_dpp v7, v22, v6 quad_perm:[2,2,2,2] row_mask:0xf bank_mask:0xf
    v_fmac_f32_dpp v37, v23, v6 quad_perm:[3,3,3,3] row_mask:0xf bank_mask:0xf
    v_add_f32 v7, v7, v37
    v_cmp_lt_f32 vcc, 0x41000000, v7
    s_cbranch_vccnz L_stub6
L_res6:
    v_exp_f32 v7, v7
    s_nop 0
    v_cvt_pk_bf16_f32 v36, v7, v7
    v_add_f32 v5, v5, v7
    v_and_b32 v24, v36, v8
    v_and_b32 v25, v36, v9
    v_and_b32 v26, v36, v10
    v_and_b32 v27, v36, v11
    s_nop 1
    v_mfma_f32_16x16x32_bf16 v[28:31], v[24:27], v[144:147], v[28:31]
    v_mfma_f32_16x16x32_bf16 v[32:35], v[24:27], v[148:151], v[32:35]
    s_waitcnt vmcnt(7)
    buffer_load_dwordx4 v[64:67], v3, s[36:39], s44 offen offset:0 nt
    v_mfma_f32_16x16x32_bf16 v[20:23], v[152:155], v[12:15], 0
    v_mfma_f32_16x16x32_bf16 v[20:23], v[156:159], v[16:19], v[20:23]
    v_mov_b32 v7, v4
    v_mov_b32 v37, 0
    s_nop 5
    v_fmac_f32_dpp v7, v20, v6 quad_perm:[0,0,0,0] row_mask:0xf bank_mask:0xf
    v_fmac_f32_dpp v37, v21, v6 quad_perm:[1,1,1,1] row_mask:0xf bank_mask:0xf
    s_nop 0
    v_fmac_f32_dpp v7, v22, v6 quad_perm:[2,2,2,2] row_mask:0xf bank_mask:0xf
    v_fmac_f32_dpp v37, v23, v6 quad_perm:[3,3,3,3] row_mask:0xf bank_mask:0xf
    v_add_f32 v7, v7, v37
    v_cmp_lt_f32 vcc, 0x41000000, v7
    s_cbranch_vccnz L_stub7
L_res7:
    v_exp_f32 v7, v7
    s_nop 0
    v_cvt_pk_bf16_f32 v36, v7, v7
    v_add_f32 v5, v5, v7
    v_and_b32 v24, v36, v8
    v_and_b32 v25, v36, v9
    v_and_b32 v26, v36, v10
    v_and_b32 v27, v36, v11
    s_nop 1
    v_mfma_f32_16x16x32_bf16 v[28:31], v[24:27], v[160:163], v[28:31]
    v_mfma_f32_16x16x32_bf16 v[32:35], v[24:27], v[164:167], v[32:35]
    s_waitcnt vmcnt(7)
    buffer_load_dwordx4 v[68:71], v3, s[36:39], s44 offen offset:256 nt
    v_mfma_f32_16x16x32_bf16 v[20:23], v[168:171], v[12:15], 0
    v_mfma_f32_16x16x32_bf16 v[20:23], v[172:175], v[16:19], v[20:23]
    v_mov_b32 v7, v4
    v_mov_b32 v37, 0
    s_nop 5
    v_fmac_f32_dpp v7, v20, v6 quad_perm:[0,0,0,0] row_mask:0xf bank_mask:0xf
    v_fmac_f32_dpp v37, v21, v6 quad_perm:[1,1,1,1] row_mask:0xf bank_mask:0xf
    s_nop 0
    v_fmac_f32_dpp v7, v22, v6 quad_perm:[2,2,2,2] row_mask:0xf bank_mask:0xf
    v_fmac_f32_dpp v37, v23, v6 quad_perm:[3,3,3,3] row_mask:0xf bank_mask:0xf
    v_add_f32 v7, v7, v37
    v_cmp_lt_f32 vcc, 0x41000000, v7
    s_cbranch_vccnz L_stub8
L_res8:
    v_exp_f32 v7, v7
    s_nop 0
    v_cvt_pk_bf16_f32 v36, v7, v7
    v_add_f32 v5, v5, v7
    v_and_b32 v24, v36, v8
    v_and_b32 v25, v36, v9
    v_and_b32 v26, v36, v10
    v_and_b32 v27, v36, v11
    s_nop 1
    v_mfma_f32_16x16x32_bf16 v[28:31], v[24:27], v[176:179], v[28:31]
    v_mfma_f32_16x16x32_bf16 v[32:35], v[24:27], v[180:183], v[32:35]
    s_waitcnt vmcnt(7)
    s_add_u32 s44, s44, 8192
    buffer_load_dwordx4 v[72:75], v2, s[32:35], s44 offen offset:0 nt
    v_mfma_f32_16x16x32_bf16 v[20:23], v[184:187], v[12:15], 0
    v_mfma_f32_16x16x32_bf16 v[20:23], v[188:191], v[16:19], v[20:23]
    v_mov_b32 v7, v4
    v_mov_b32 v37, 0
    s_nop 5
    v_fmac_f32_dpp v7, v20, v6 quad_perm:[0,0,0,0] row_mask:0xf bank_mask:0xf
    v_fmac_f32_dpp v37, v21, v6 quad_perm:[1,1,1,1] row_mask:0xf bank_mask:0xf
    s_nop 0
    v_fmac_f32_dpp v7, v22, v6 quad_perm:[2,2,2,2] row_mask:0xf bank_mask:0xf
    v_fmac_f32_dpp v37, v23, v6 quad_perm:[3,3,3,3] row_mask:0xf bank_mask:0xf
    v_add_f32 v7, v7, v37
    v_cmp_lt_f32 vcc, 0x41000000, v7
    s_cbranch_vccnz L_stub9
L_res9:
    v_exp_f32 v7, v7
    s_nop 0
    v_cvt_pk_bf16_f32 v36, v7, v7
    v_add_f32 v5, v5, v7
    v_and_b32 v24, v36, v8
    v_and_b32 v25, v36, v9
    v_and_b32 v26, v36, v10
    v_and_b32 v27, v36, v11
    s_nop 1
    v_mfma_f32_16x16x32_bf16 v[28:31], v[24:27], v[192:195], v[28:31]
    v_mfma_f32_16x16x32_bf16 v[32:35], v[24:27], v[196:199], v[32:35]
    s_waitcnt vmcnt(7)
    buffer_load_dwordx4 v[76:79], v2, s[32:35], s44 offen offset:256 nt
    v_mfma_f32_16x16x32_bf16 v[20:23], v[200:203], v[12:15], 0
    v_mfma_f32_16x16x32_bf16 v[20:23], v[204:207], v[16:19], v[20:23]
    v_mov_b32 v7, v4
    v_mov_b32 v37, 0
    s_nop 5
    v_fmac_f32_dpp v7, v20, v6 quad_perm:[0,0,0,0] row_mask:0xf bank_mask:0xf
    v_fmac_f32_dpp v37, v21, v6 quad_perm:[1,1,1,1] row_mask:0xf bank_mask:0xf
    s_nop 0
    v_fmac_f32_dpp v7, v22, v6 quad_perm:[2,2,2,2] row_mask:0xf bank_mask:0xf
    v_fmac_f32_dpp v37, v23, v6 quad_perm:[3,3,3,3] row_mask:0xf bank_mask:0xf
    v_add_f32 v7, v7, v37
    v_cmp_lt_f32 vcc, 0x41000000, v7
    s_cbranch_vccnz L_stub10
L_res10:
    v_exp_f32 v7, v7
    s_nop 0
    v_cvt_pk_bf16_f32 v36, v7, v7
    v_add_f32 v5, v5, v7
    v_and_b32 v24, v36, v8
    v_and_b32 v25, v36, v9
    v_and_b32 v26, v36, v10
    v_and_b32 v27, v36, v11
    s_nop 1
    v_mfma_f32_16x16x32_bf16 v[28:31], v[24:27], v[208:211], v[28:31]
    v_mfma_f32_16x16x32_bf16 v[32:35], v[24:27], v[212:215], v[32:35]
    s_waitcnt vmcnt(7)
    buffer_load_dwordx4 v[80:83], v3, s[36:39], s44 offen offset:0 nt
    v_mfma_f32_16x16x32_bf16 v[20:23], v[216:219], v[12:15], 0
    v_mfma_f32_16x16x32_bf16 v[20:23], v[220:223], v[16:19], v[20:23]
    v_mov_b32 v7, v4
    v_mov_b32 v37, 0
    s_nop 5
    v_fmac_f32_dpp v7, v20, v6 quad_perm:[0,0,0,0] row_mask:0xf bank_mask:0xf
    v_fmac_f32_dpp v37, v21, v6 quad_perm:[1,1,1,1] row_mask:0xf bank_mask:0xf
    s_nop 0
    v_fmac_f32_dpp v7, v22, v6 quad_perm:[2,2,2,2] row_mask:0xf bank_mask:0xf
    v_fmac_f32_dpp v37, v23, v6 quad_perm:[3,3,3,3] row_mask:0xf bank_mask:0xf
    v_add_f32 v7, v7, v37
    v_cmp_lt_f32 vcc, 0x41000000, v7
    s_cbranch_vccnz L_stub11
L_res11:
    v_exp_f32 v7, v7
    s_nop 0
    v_cvt_pk_bf16_f32 v36, v7, v7
    v_add_f32 v5, v5, v7
    v_and_b32 v24, v36, v8
    v_and_b32 v25, v36, v9
    v_and_b32 v26, v36, v10
    v_and_b32 v27, v36, v11
    s_nop 1
    v_mfma_f32_16x16x32_bf16 v[28:31], v[24:27], v[224:227], v[28:31]
    v_mfma_f32_16x16x32_bf16 v[32:35], v[24:27], v[228:231], v[32:35]
    s_waitcnt vmcnt(7)
    buffer_load_dwordx4 v[84:87], v3, s[36:39], s44 offen offset:256 nt
    v_mfma_f32_16x16x32_bf16 v[20:23], v[232:235], v[12:15], 0
    v_mfma_f32_16x16x32_bf16 v[20:23], v[236:239], v[16:19], v[20:23]
    v_mov_b32 v7, v4
    v_mov_b32 v37, 0
    s_nop 5
    v_fmac_f32_dpp v7, v20, v6 quad_perm:[0,0,0,0] row_mask:0xf bank_mask:0xf
    v_fmac_f32_dpp v37, v21, v6 quad_perm:[1,1,1,1] row_mask:0xf bank_mask:0xf
    s_nop 0
    v_fmac_f32_dpp v7, v22, v6 quad_perm:[2,2,2,2] row_mask:0xf bank_mask:0xf
    v_fmac_f32_dpp v37, v23, v6 quad_perm:[3,3,3,3] row_mask:0xf bank_mask:0xf
    v_add_f32 v7, v7, v37
    v_cmp_lt_f32 vcc, 0x41000000, v7
    s_cbranch_vccnz L_stub12
L_res12:
    v_exp_f32 v7, v7
    s_nop 0
    v_cvt_pk_bf16_f32 v36, v7, v7
    v_add_f32 v5, v5, v7
    v_and_b32 v24, v36, v8
    v_and_b32 v25, v36, v9
    v_and_b32 v26, v36, v10
    v_and_b32 v27, v36, v11
    s_nop 1
    v_mfma_f32_16x16x32_bf16 v[28:31], v[24:27], v[240:243], v[28:31]
    v_mfma_f32_16x16x32_bf16 v[32:35], v[24:27], v[244:247], v[32:35]
    s_waitcnt vmcnt(7)
    s_add_u32 s44, s44, 8192
    buffer_load_dwordx4 v[88:91], v2, s[32:35], s44 offen offset:0 nt
    v_mfma_f32_16x16x32_bf16 v[20:23], v[40:43], v[12:15], 0
    v_mfma_f32_16x16x32_bf16 v[20:23], v[44:47], v[16:19], v[20:23]
    v_mov_b32 v7, v4
    v_mov_b32 v37, 0
    s_nop 5
    v_fmac_f32_dpp v7, v20, v6 quad_perm:[0,0,0,0] row_mask:0xf bank_mask:0xf
    v_fmac_f32_dpp v37, v21, v6 quad_perm:[1,1,1,1] row_mask:0xf bank_mask:0xf
    s_nop 0
    v_fmac_f32_dpp v7, v22, v6 quad_perm:[2,2,2,2] row_mask:0xf bank_mask:0xf
    v_fmac_f32_dpp v37, v23, v6 quad_perm:[3,3,3,3] row_mask:0xf bank_mask:0xf
    v_add_f32 v7, v7, v37
    v_cmp_lt_f32 vcc, 0x41000000, v7
    s_cbranch_vccnz L_stub13
L_res13:
    v_exp_f32 v7, v7
    s_nop 0
    v_cvt_pk_bf16_f32 v36, v7, v7
    v_add_f32 v5, v5, v7
    v_and_b32 v24, v36, v8
    v_and_b32 v25, v36, v9
    v_and_b32 v26, v36, v10
    v_and_b32 v27, v36, v11
    s_nop 1
    v_mfma_f32_16x16x32_bf16 v[28:31], v[24:27], v[48:51], v[28:31]
    v_mfma_f32_16x16x32_bf16 v[32:35], v[24:27], v[52:55], v[32:35]
    s_waitcnt vmcnt(7)
    buffer_load_dwordx4 v[92:95], v2, s[32:35], s44 offen offset:256 nt
    s_waitcnt vmcnt(7)
    buffer_load_dwordx4 v[96:99], v3, s[36:39], s44 offen offset:0 nt
    s_waitcnt vmcnt(7)
    buffer_load_dwordx4 v[100:103], v3, s[36:39], s44 offen offset:256 nt
    v_mfma_f32_16x16x32_bf16 v[20:23], v[56:59], v[12:15], 0
    v_mfma_f32_16x16x32_bf16 v[20:23], v[60:63], v[16:19], v[20:23]
    v_mov_b32 v7, v4
    v_mov_b32 v37, 0
    s_nop 5
    v_fmac_f32_dpp v7, v20, v6 quad_perm:[0,0,0,0] row_mask:0xf bank_mask:0xf
    v_fmac_f32_dpp v37, v21, v6 quad_perm:[1,1,1,1] row_mask:0xf bank_mask:0xf
    s_nop 0
    v_fmac_f32_dpp v7, v22, v6 quad_perm:[2,2,2,2] row_mask:0xf bank_mask:0xf
    v_fmac_f32_dpp v37, v23, v6 quad_perm:[3,3,3,3] row_mask:0xf bank_mask:0xf
    v_add_f32 v7, v7, v37
    v_cmp_lt_f32 vcc, 0x41000000, v7
    s_cbranch_vccnz L_stub14
L_res14:
    v_exp_f32 v7, v7
    s_nop 0
    v_cvt_pk_bf16_f32 v36, v7, v7
    v_add_f32 v5, v5, v7
    v_and_b32 v24, v36, v8
    v_and_b32 v25, v36, v9
    v_and_b32 v26, v36, v10
    v_and_b32 v27, v36, v11
    s_nop 1
    v_mfma_f32_16x16x32_bf16 v[28:31], v[24:27], v[64:67], v[28:31]
    v_mfma_f32_16x16x32_bf16 v[32:35], v[24:27], v[68:71], v[32:35]
    s_waitcnt vmcnt(7)
    s_add_u32 s44, s44, 8192
    buffer_load_dwordx4 v[104:107], v2, s[32:35], s44 offen offset:0 nt
    s_waitcnt vmcnt(7)
    buffer_load_dwordx4 v[108:111], v2, s[32:35], s44 offen offset:256 nt
    v_mfma_f32_16x16x32_bf16 v[20:23], v[72:75], v[12:15], 0
    v_mfma_f32_16x16x32_bf16 v[20:23], v[76:79], v[16:19], v[20:23]
    v_mov_b32 v7, v4
    v_mov_b32 v37, 0
    s_waitcnt vmcnt(7)
    buffer_load_dwordx4 v[112:115], v3, s[36:39], s44 offen offset:0 nt
    s_nop 3
    v_fmac_f32_dpp v7, v20, v6 quad_perm:[0,0,0,0] row_mask:0xf bank_mask:0xf
    v_fmac_f32_dpp v37, v21, v6 quad_perm:[1,1,1,1] row_mask:0xf bank_mask:0xf
    s_nop 0
    v_fmac_f32_dpp v7, v22, v6 quad_perm:[2,2,2,2] row_mask:0xf bank_mask:0xf
    v_fmac_f32_dpp v37, v23, v6 quad_perm:[3,3,3,3] row_mask:0xf bank_mask:0xf
    v_add_f32 v7, v7, v37
    v_cmp_lt_f32 vcc, 0x41000000, v7
    s_cbranch_vccnz L_stub15
L_res15:
    v_exp_f32 v7, v7
    s_nop 0
    v_cvt_pk_bf16_f32 v36, v7, v7
    v_add_f32 v5, v5, v7
    v_and_b32 v24, v36, v8
    v_and_b32 v25, v36, v9
    v_and_b32 v26, v36, v10
    v_and_b32 v27, v36, v11
    s_waitcnt vmcnt(7)
    buffer_load_dwordx4 v[116:119], v3, s[36:39], s44 offen offset:256 nt
    v_mfma_f32_16x16x32_bf16 v[28:31], v[24:27], v[80:83], v[28:31]
    v_mfma_f32_16x16x32_bf16 v[32:35], v[24:27], v[84:87], v[32:35]
    s_waitcnt vmcnt(7)
    s_add_u32 s44, s44, 8192
    buffer_load_dwordx4 v[120:123], v2, s[32:35], s44 offen offset:0 nt
    s_waitcnt vmcnt(7)
    buffer_load_dwordx4 v[124:127], v2, s[32:35], s44 offen offset:256 nt
    v_mfma_f32_16x16x32_bf16 v[20:23], v[88:91], v[12:15], 0
    v_mfma_f32_16x16x32_bf16 v[20:23], v[92:95], v[16:19], v[20:23]
    v_mov_b32 v7, v4
    v_mov_b32 v37, 0
    s_waitcnt vmcnt(7)
    buffer_load_dwordx4 v[128:131], v3, s[36:39], s44 offen offset:0 nt
    s_nop 3
    v_fmac_f32_dpp v7, v20, v6 quad_perm:[0,0,0,0] row_mask:0xf bank_mask:0xf
    v_fmac_f32_dpp v37, v21, v6 quad_perm:[1,1,1,1] row_mask:0xf bank_mask:0xf
    s_nop 0
    v_fmac_f32_dpp v7, v22, v6 quad_perm:[2,2,2,2] row_mask:0xf bank_mask:0xf
    v_fmac_f32_dpp v37, v23, v6 quad_perm:[3,3,3,3] row_mask:0xf bank_mask:0xf
    v_add_f32 v7, v7, v37
    v_cmp_lt_f32 vcc, 0x41000000, v7
    s_cbranch_vccnz L_stub16
L_res16:
    v_exp_f32 v7, v7
    s_nop 0
    v_cvt_pk_bf16_f32 v36, v7, v7
    v_add_f32 v5, v5, v7
    v_and_b32 v24, v36, v8
    v_and_b32 v25, v36, v9
    v_and_b32 v26, v36, v10
    v_and_b32 v27, v36, v11
    s_waitcnt vmcnt(7)
    buffer_load_dwordx4 v[132:135], v3, s[36:39], s44 offen offset:256 nt
    v_mfma_f32_16x16x32_bf16 v[28:31], v[24:27], v[96:99], v[28:31]
    v_mfma_f32_16x16x32_bf16 v[32:35], v[24:27], v[100:103], v[32:35]
    s_waitcnt vmcnt(7)
    s_add_u32 s44, s44, 8192
    buffer_load_dwordx4 v[136:139], v2, s[32:35], s44 offen offset:0 nt
    s_waitcnt vmcnt(7)
    buffer_load_dwordx4 v[140:143], v2, s[32:35], s44 offen offset:256 nt
    v_mfma_f32_16x16x32_bf16 v[20:23], v[104:107], v[12:15], 0
    v_mfma_f32_16x16x32_bf16 v[20:23], v[108:111], v[16:19], v[20:23]
    v_mov_b32 v7, v4
    v_mov_b32 v37, 0
    s_waitcnt vmcnt(7)
    buffer_load_dwordx4 v[144:147], v3, s[36:39], s44 offen offset:0 nt
    s_nop 3
    v_fmac_f32_dpp v7, v20, v6 quad_perm:[0,0,0,0] row_mask:0xf bank_mask:0xf
    v_fmac_f32_dpp v37, v21, v6 quad_perm:[1,1,1,1] row_mask:0xf bank_mask:0xf
    s_nop 0
    v_fmac_f32_dpp v7, v22, v6 quad_perm:[2,2,2,2] row_mask:0xf bank_mask:0xf
    v_fmac_f32_dpp v37, v23, v6 quad_perm:[3,3,3,3] row_mask:0xf bank_mask:0xf
    v_add_f32 v7, v7, v37
    v_cmp_lt_f32 vcc, 0x41000000, v7
    s_cbranch_vccnz L_stub17
L_res17:
    v_exp_f32 v7, v7
    s_nop 0
    v_cvt_pk_bf16_f32 v36, v7, v7
    v_add_f32 v5, v5, v7
    v_and_b32 v24, v36, v8
    v_and_b32 v25, v36, v9
    v_and_b32 v26, v36, v10
    v_and_b32 v27, v36, v11
    s_waitcnt vmcnt(7)
    buffer_load_dwordx4 v[148:151], v3, s[36:39], s44 offen offset:256 nt
    v_mfma_f32_16x16x32_bf16 v[28:31], v[24:27], v[112:115], v[28:31]
    v_mfma_f32_16x16x32_bf16 v[32:35], v[24:27], v[116:119], v[32:35]
    s_waitcnt vmcnt(7)
    s_add_u32 s44, s44, 8192
    buffer_load_dwordx4 v[152:155], v2, s[32:35], s44 offen offset:0 nt
    s_waitcnt vmcnt(7)
    buffer_load_dwordx4 v[156:159], v2, s[32:35], s44 offen offset:256 nt
    v_mfma_f32_16x16x32_bf16 v[20:23], v[120:123], v[12:15], 0
    v_mfma_f32_16x16x32_bf16 v[20:23], v[124:127], v[16:19], v[20:23]
    v_mov_b32 v7, v4
    v_mov_b32 v37, 0
    s_waitcnt vmcnt(7)
    buffer_load_dwordx4 v[160:163], v3, s[36:39], s44 offen offset:0 nt
    s_nop 3
    v_fmac_f32_dpp v7, v20, v6 quad_perm:[0,0,0,0] row_mask:0xf bank_mask:0xf
    v_fmac_f32_dpp v37, v21, v6 quad_perm:[1,1,1,1] row_mask:0xf bank_mask:0xf
    s_nop 0
    v_fmac_f32_dpp v7, v22, v6 quad_perm:[2,2,2,2] row_mask:0xf bank_mask:0xf
    v_fmac_f32_dpp v37, v23, v6 quad_perm:[3,3,3,3] row_mask:0xf bank_mask:0xf
    v_add_f32 v7, v7, v37
    v_cmp_lt_f32 vcc, 0x41000000, v7
    s_cbranch_vccnz L_stub18
L_res18:
    v_exp_f32 v7, v7
    s_nop 0
    v_cvt_pk_bf16_f32 v36, v7, v7
    v_add_f32 v5, v5, v7
    v_and_b32 v24, v36, v8
    v_and_b32 v25, v36, v9
    v_and_b32 v26, v36, v10
    v_and_b32 v27, v36, v11
    s_waitcnt vmcnt(7)
    buffer_load_dwordx4 v[164:167], v3, s[36:39], s44 offen offset:256 nt
    v_mfma_f32_16x16x32_bf16 v[28:31], v[24:27], v[128:131], v[28:31]
    v_mfma_f32_16x16x32_bf16 v[32:35], v[24:27], v[132:135], v[32:35]
    s_waitcnt vmcnt(7)
    s_add_u32 s44, s44, 8192
    buffer_load_dwordx4 v[168:171], v2, s[32:35], s44 offen offset:0 nt
    s_waitcnt vmcnt(7)
    buffer_load_dwordx4 v[172:175], v2, s[32:35], s44 offen offset:256 nt
    v_mfma_f32_16x16x32_bf16 v[20:23], v[136:139], v[12:15], 0
    v_mfma_f32_16x16x32_bf16 v[20:23], v[140:143], v[16:19], v[20:23]
    v_mov_b32 v7, v4
    v_mov_b32 v37, 0
    s_waitcnt vmcnt(7)
    buffer_load_dwordx4 v[176:179], v3, s[36:39], s44 offen offset:0 nt
    s_nop 3
    v_fmac_f32_dpp v7, v20, v6 quad_perm:[0,0,0,0] row_mask:0xf bank_mask:0xf
    v_fmac_f32_dpp v37, v21, v6 quad_perm:[1,1,1,1] row_mask:0xf bank_mask:0xf
    s_nop 0
    v_fmac_f32_dpp v7, v22, v6 quad_perm:[2,2,2,2] row_mask:0xf bank_mask:0xf
    v_fmac_f32_dpp v37, v23, v6 quad_perm:[3,3,3,3] row_mask:0xf bank_mask:0xf
    v_add_f32 v7, v7, v37
    v_cmp_lt_f32 vcc, 0x41000000, v7
    s_cbranch_vccnz L_stub19
L_res19:
    v_exp_f32 v7, v7
    s_nop 0
    v_cvt_pk_bf16_f32 v36, v7, v7
    v_add_f32 v5, v5, v7
    v_and_b32 v24, v36, v8
    v_and_b32 v25, v36, v9
    v_and_b32 v26, v36, v10
    v_and_b32 v27, v36, v11
    s_waitcnt vmcnt(7)
    buffer_load_dwordx4 v[180:183], v3, s[36:39], s44 offen offset:256 nt
    v_mfma_f32_16x16x32_bf16 v[28:31], v[24:27], v[144:147], v[28:31]
    v_mfma_f32_16x16x32_bf16 v[32:35], v[24:27], v[148:151], v[32:35]
    s_waitcnt vmcnt(7)
    s_add_u32 s44, s44, 8192
    v_mov_b32 v38, 22
    s_mov_b64 exec, 1
    ds_max_u32 v0, v38 offset:11776
    s_mov_b64 exec, -1
    buffer_load_dwordx4 v[184:187], v2, s[32:35], s44 offen offset:0 nt
    s_waitcnt vmcnt(7)
    buffer_load_dwordx4 v[188:191], v2, s[32:35], s44 offen offset:256 nt
    v_mfma_f32_16x16x32_bf16 v[20:23], v[152:155], v[12:15], 0
    v_mfma_f32_16x16x32_bf16 v[20:23], v[156:159], v[16:19], v[20:23]
    v_mov_b32 v7, v4
    v_mov_b32 v37, 0
    s_waitcnt vmcnt(7)
    buffer_load_dwordx4 v[192:195], v3, s[36:39], s44 offen offset:0 nt
    s_nop 3
    v_fmac_f32_dpp v7, v20, v6 quad_perm:[0,0,0,0] row_mask:0xf bank_mask:0xf
    v_fmac_f32_dpp v37, v21, v6 quad_perm:[1,1,1,1] row_mask:0xf bank_mask:0xf
    s_nop 0
    v_fmac_f32_dpp v7, v22, v6 quad_perm:[2,2,2,2] row_mask:0xf bank_mask:0xf
    v_fmac_f32_dpp v37, v23, v6 quad_perm:[3,3,3,3] row_mask:0xf bank_mask:0xf
    v_add_f32 v7, v7, v37
    v_cmp_lt_f32 vcc, 0x41000000, v7
    s_cbranch_vccnz L_stub20
L_res20:
    v_exp_f32 v7, v7
    s_nop 0
    v_cvt_pk_bf16_f32 v36, v7, v7
    v_add_f32 v5, v5, v7
    v_and_b32 v24, v36, v8
    v_and_b32 v25, v36, v9
    v_and_b32 v26, v36, v10
    v_and_b32 v27, v36, v11
    s_waitcnt vmcnt(7)
    buffer_load_dwordx4 v[196:199], v3, s[36:39], s44 offen offset:256 nt
    v_mfma_f32_16x16x32_bf16 v[28:31], v[24:27], v[160:163], v[28:31]
    v_mfma_f32_16x16x32_bf16 v[32:35], v[24:27], v[164:167], v[32:35]
    s_waitcnt vmcnt(7)
    s_add_u32 s44, s44, 8192
    v_mov_b32 v38, 23
    s_mov_b64 exec, 1
    ds_max_u32 v0, v38 offset:11776
    s_mov_b64 exec, -1
    buffer_load_dwordx4 v[200:203], v2, s[32:35], s44 offen offset:0 nt
    s_waitcnt vmcnt(7)
    buffer_load_dwordx4 v[204:207], v2, s[32:35], s44 offen offset:256 nt
    v_mfma_f32_16x16x32_bf16 v[20:23], v[168:171], v[12:15], 0
    v_mfma_f32_16x16x32_bf16 v[20:23], v[172:175], v[16:19], v[20:23]
    v_mov_b32 v7, v4
    v_mov_b32 v37, 0
    s_waitcnt vmcnt(7)
    buffer_load_dwordx4 v[208:211], v3, s[36:39], s44 offen offset:0 nt
    s_nop 3
    v_fmac_f32_dpp v7, v20, v6 quad_perm:[0,0,0,0] row_mask:0xf bank_mask:0xf
    v_fmac_f32_dpp v37, v21, v6 quad_perm:[1,1,1,1] row_mask:0xf bank_mask:0xf
    s_nop 0
    v_fmac_f32_dpp v7, v22, v6 quad_perm:[2,2,2,2] row_mask:0xf bank_mask:0xf
    v_fmac_f32_dpp v37, v23, v6 quad_perm:[3,3,3,3] row_mask:0xf bank_mask:0xf
    v_add_f32 v7, v7, v37
    v_cmp_lt_f32 vcc, 0x41000000, v7
    s_cbranch_vccnz L_stub21
L_res21:
    v_exp_f32 v7, v7
    s_nop 0
    v_cvt_pk_bf16_f32 v36, v7, v7
    v_add_f32 v5, v5, v7
    v_and_b32 v24, v36, v8
    v_and_b32 v25, v36, v9
    v_and_b32 v26, v36, v10
    v_and_b32 v27, v36, v11
    s_waitcnt vmcnt(7)
    buffer_load_dwordx4 v[212:215], v3, s[36:39], s44 offen offset:256 nt
    v_mfma_f32_16x16x32_bf16 v[28:31], v[24:27], v[176:179], v[28:31]
    v_mfma_f32_16x16x32_bf16 v[32:35], v[24:27], v[180:183], v[32:35]
    s_mov_b32 s46, 0
    s_mov_b32 s47, 24
    v_mov_b32 v39, s46
    ds_read_b32 v38, v39 offset:11264
    s_nop 3
L_dyn0:
    s_mov_b32 s62, 200000
L_dq0:
    s_waitcnt lgkmcnt(0)
    v_readfirstlane_b32 s44, v38
    s_nop 0
    s_cmp_lt_u32 s44, 0xfffffffe
    s_cbranch_scc1 L_dgo0
    s_cmp_eq_u32 s44, 0xffffffff
    s_cbranch_scc1 L_drain0
    s_sub_u32 s62, s62, 1
    s_cmp_eq_u32 s62, 0
    s_cbranch_scc1 L_drain0
    s_sleep 1
    ds_read_b32 v38, v39 offset:11264
    s_branch L_dq0
L_dgo0:
    v_mov_b32 v38, s47
    s_mov_b64 exec, 1
    ds_max_u32 v0, v38 offset:11776
    s_mov_b64 exec, -1
    s_waitcnt vmcnt(7)
    buffer_load_dwordx4 v[216:219], v2, s[32:35], s44 offen offset:0 nt
    s_waitcnt vmcnt(7)
    buffer_load_dwordx4 v[220:223], v2, s[32:35], s44 offen offset:256 nt
    v_mfma_f32_16x16x32_bf16 v[20:23], v[184:187], v[12:15], 0
    v_mfma_f32_16x16x32_bf16 v[20:23], v[188:191], v[16:19], v[20:23]
    v_mov_b32 v7, v4
    v_mov_b32 v37, 0
    s_waitcnt vmcnt(7)
    buffer_load_dwordx4 v[224:227], v3, s[36:39], s44 offen offset:0 nt
    s_nop 3
    v_fmac_f32_dpp v7, v20, v6 quad_perm:[0,0,0,0] row_mask:0xf bank_mask:0xf
    v_fmac_f32_dpp v37, v21, v6 quad_perm:[1,1,1,1] row_mask:0xf bank_mask:0xf
    s_nop 0
    v_fmac_f32_dpp v7, v22, v6 quad_perm:[2,2,2,2] row_mask:0xf bank_mask:0xf
    v_fmac_f32_dpp v37, v23, v6 quad_perm:[3,3,3,3] row_mask:0xf bank_mask:0xf
    v_add_f32 v7, v7, v37
    v_cmp_lt_f32 vcc, 0x41000000, v7
    s_cbranch_vccnz L_stubd0
L_resd0:
    v_exp_f32 v7, v7
    s_nop 0
    v_cvt_pk_bf16_f32 v36, v7, v7
    v_add_f32 v5, v5, v7
    v_and_b32 v24, v36, v8
    v_and_b32 v25, v36, v9
    v_and_b32 v26, v36, v10
    v_and_b32 v27, v36, v11
    s_waitcnt vmcnt(7)
    buffer_load_dwordx4 v[228:231], v3, s[36:39], s44 offen offset:256 nt
    v_mfma_f32_16x16x32_bf16 v[28:31], v[24:27], v[192:195], v[28:31]
    v_mfma_f32_16x16x32_bf16 v[32:35], v[24:27], v[196:199], v[32:35]
    s_add_u32 s46, s46, 4
    s_add_u32 s47, s47, 1
    v_mov_b32 v39, s46
    ds_read_b32 v38, v39 offset:11264
    s_nop 3
L_dyn1:
    s_mov_b32 s62, 200000
L_dq1:
    s_waitcnt lgkmcnt(0)
    v_readfirstlane_b32 s44, v38
    s_nop 0
    s_cmp_lt_u32 s44, 0xfffffffe
    s_cbranch_scc1 L_dgo1
    s_cmp_eq_u32 s44, 0xffffffff
    s_cbranch_scc1 L_drain1
    s_sub_u32 s62, s62, 1
    s_cmp_eq_u32 s62, 0
    s_cbranch_scc1 L_drain1
    s_sleep 1
    ds_read_b32 v38, v39 offset:11264
    s_branch L_dq1
L_dgo1:
    v_mov_b32 v38, s47
    s_mov_b64 exec, 1
    ds_max_u32 v0, v38 offset:11776
    s_mov_b64 exec, -1
    s_waitcnt vmcnt(7)
    buffer_load_dwordx4 v[184:187], v2, s[32:35], s44 offen offset:0 nt
    s_waitcnt vmcnt(7)
    buffer_load_dwordx4 v[188:191], v2, s[32:35], s44 offen offset:256 nt
    v_mfma_f32_16x16x32_bf16 v[20:23], v[200:203], v[12:15], 0
    v_mfma_f32_16x16x32_bf16 v[20:23], v[204:207], v[16:19], v[20:23]
    v_mov_b32 v7, v4
    v_mov_b32 v37, 0
    s_waitcnt vmcnt(7)
    buffer_load_dwordx4 v[192:195], v3, s[36:39], s44 offen offset:0 nt
    s_nop 3
    v_fmac_f32_dpp v7, v20, v6 quad_perm:[0,0,0,0] row_mask:0xf bank_mask:0xf
    v_fmac_f32_dpp v37, v21, v6 quad_perm:[1,1,1,1] row_mask:0xf bank_mask:0xf
    s_nop 0
    v_fmac_f32_dpp v7, v22, v6 quad_perm:[2,2,2,2] row_mask:0xf bank_mask:0xf
    v_fmac_f32_dpp v37, v23, v6 quad_perm:[3,3,3,3] row_mask:0xf bank_mask:0xf
    v_add_f32 v7, v7, v37
    v_cmp_lt_f32 vcc, 0x41000000, v7
    s_cbranch_vccnz L_stubd1
L_resd1:
    v_exp_f32 v7, v7
    s_nop 0
    v_cvt_pk_bf16_f32 v36, v7, v7
    v_add_f32 v5, v5, v7
    v_and_b32 v24, v36, v8
    v_and_b32 v25, v36, v9
    v_and_b32 v26, v36, v10
    v_and_b32 v27, v36, v11
    s_waitcnt vmcnt(7)
    buffer_load_dwordx4 v[196:199], v3, s[36:39], s44 offen offset:256 nt
    v_mfma_f32_16x16x32_bf16 v[28:31], v[24:27], v[208:211], v[28:31]
    v_mfma_f32_16x16x32_bf16 v[32:35], v[24:27], v[212:215], v[32:35]
    s_add_u32 s46, s46, 4
    s_add_u32 s47, s47, 1
    v_mov_b32 v39, s46
    ds_read_b32 v38, v39 offset:11264
    s_nop 3
L_dyn2:
    s_mov_b32 s62, 200000
L_dq2:
    s_waitcnt lgkmcnt(0)
    v_readfirstlane_b32 s44, v38
    s_nop 0
    s_cmp_lt_u32 s44, 0xfffffffe
    s_cbranch_scc1 L_dgo2
    s_cmp_eq_u32 s44, 0xffffffff
    s_cbranch_scc1 L_drain2
    s_sub_u32 s62, s62, 1
    s_cmp_eq_u32 s62, 0
    s_cbranch_scc1 L_drain2
    s_sleep 1
    ds_read_b32 v38, v39 offset:11264
    s_branch L_dq2
L_dgo2:
    v_mov_b32 v38, s47
    s_mov_b64 exec, 1
    ds_max_u32 v0, v38 offset:11776
    s_mov_b64 exec, -1
    s_waitcnt vmcnt(7)
    buffer_load_dwordx4 v[200:203], v2, s[32:35], s44 offen offset:0 nt
    s_waitcnt vmcnt(7)
    buffer_load_dwordx4 v[204:207], v2, s[32:35], s44 offen offset:256 nt
    v_mfma_f32_16x16x32_bf16 v[20:23], v[216:219], v[12:15], 0
    v_mfma_f32_16x16x32_bf16 v[20:23], v[220:223], v[16:19], v[20:23]
    v_mov_b32 v7, v4
    v_mov_b32 v37, 0
    s_waitcnt vmcnt(7)
    buffer_load_dwordx4 v[208:211], v3, s[36:39], s44 offen offset:0 nt
    s_nop 3
    v_fmac_f32_dpp v7, v20, v6 quad_perm:[0,0,0,0] row_mask:0xf bank_mask:0xf
    v_fmac_f32_dpp v37, v21, v6 quad_perm:[1,1,1,1] row_mask:0xf bank_mask:0xf
    s_nop 0
    v_fmac_f32_dpp v7, v22, v6 quad_perm:[2,2,2,2] row_mask:0xf bank_mask:0xf
    v_fmac_f32_dpp v37, v23, v6 quad_perm:[3,3,3,3] row_mask:0xf bank_mask:0xf
    v_add_f32 v7, v7, v37
    v_cmp_lt_f32 vcc, 0x41000000, v7
    s_cbranch_vccnz L_stubd2
L_resd2:
    v_exp_f32 v7, v7
    s_nop 0
    v_cvt_pk_bf16_f32 v36, v7, v7
    v_add_f32 v5, v5, v7
    v_and_b32 v24, v36, v8
    v_and_b32 v25, v36, v9
    v_and_b32 v26, v36, v10
    v_and_b32 v27, v36, v11
    s_waitcnt vmcnt(7)
    buffer_load_dwordx4 v[212:215], v3, s[36:39], s44 offen offset:256 nt
    v_mfma_f32_16x16x32_bf16 v[28:31], v[24:27], v[224:227], v[28:31]
    v_mfma_f32_16x16x32_bf16 v[32:35], v[24:27], v[228:231], v[32:35]
    s_add_u32 s46, s46, 4
    s_add_u32 s47, s47, 1
    v_mov_b32 v39, s46
    ds_read_b32 v38, v39 offset:11264
    s_branch L_dyn0
    s_nop 2
L_drain0:
    v_mov_b32 v38, 1
    ds_write_b32 v0, v38 offset:10508
    s_waitcnt vmcnt(6)
    v_mfma_f32_16x16x32_bf16 v[20:23], v[184:187], v[12:15], 0
    v_mfma_f32_16x16x32_bf16 v[20:23], v[188:191], v[16:19], v[20:23]
    v_mov_b32 v7, v4
    v_mov_b32 v37, 0
    s_nop 5
    v_fmac_f32_dpp v7, v20, v6 quad_perm:[0,0,0,0] row_mask:0xf bank_mask:0xf
    v_fmac_f32_dpp v37, v21, v6 quad_perm:[1,1,1,1] row_mask:0xf bank_mask:0xf
    s_nop 0
    v_fmac_f32_dpp v7, v22, v6 quad_perm:[2,2,2,2] row_mask:0xf bank_mask:0xf
    v_fmac_f32_dpp v37, v23, v6 quad_perm:[3,3,3,3] row_mask:0xf bank_mask:0xf
    v_add_f32 v7, v7, v37
    v_cmp_lt_f32 vcc, 0x41000000, v7
    s_cbranch_vccnz L_stube0_2
L_rese0_2:
    v_exp_f32 v7, v7
    s_nop 0
    v_cvt_pk_bf16_f32 v36, v7, v7
    v_add_f32 v5, v5, v7
    v_and_b32 v24, v36, v8
    v_and_b32 v25, v36, v9
    v_and_b32 v26, v36, v10
    v_and_b32 v27, v36, v11
    s_waitcnt vmcnt(4)
    s_nop 0
    v_mfma_f32_16x16x32_bf16 v[28:31], v[24:27], v[192:195], v[28:31]
    v_mfma_f32_16x16x32_bf16 v[32:35], v[24:27], v[196:199], v[32:35]
    s_waitcnt vmcnt(2)
    v_mfma_f32_16x16x32_bf16 v[20:23], v[200:203], v[12:15], 0
    v_mfma_f32_16x16x32_bf16 v[20:23], v[204:207], v[16:19], v[20:23]
    v_mov_b32 v7, v4
    v_mov_b32 v37, 0
    s_nop 5
    v_fmac_f32_dpp v7, v20, v6 quad_perm:[0,0,0,0] row_mask:0xf bank_mask:0xf
    v_fmac_f32_dpp v37, v21, v6 quad_perm:[1,1,1,1] row_mask:0xf bank_mask:0xf
    s_nop 0
    v_fmac_f32_dpp v7, v22, v6 quad_perm:[2,2,2,2] row_mask:0xf bank_mask:0xf
    v_fmac_f32_dpp v37, v23, v6 quad_perm:[3,3,3,3] row_mask:0xf bank_mask:0xf
    v_add_f32 v7, v7, v37
    v_cmp_lt_f32 vcc, 0x41000000, v7
    s_cbranch_vccnz L_stube0_1
L_rese0_1:
    v_exp_f32 v7, v7
    s_nop 0
    v_cvt_pk_bf16_f32 v36, v7, v7
    v_add_f32 v5, v5, v7
    v_and_b32 v24, v36, v8
    v_and_b32 v25, v36, v9
    v_and_b32 v26, v36, v10
    v_and_b32 v27, v36, v11
    s_waitcnt vmcnt(0)
    s_nop 0
    v_mfma_f32_16x16x32_bf16 v[28:31], v[24:27], v[208:211], v[28:31]
    v_mfma_f32_16x16x32_bf16 v[32:35], v[24:27], v[212:215], v[32:35]
    s_branch L_sdone
    s_nop 6
L_drain1:
    v_mov_b32 v38, 1
    ds_write_b32 v0, v38 offset:10508
    s_waitcnt vmcnt(6)
    v_mfma_f32_16x16x32_bf16 v[20:23], v[200:203], v[12:15], 0
    v_mfma_f32_16x16x32_bf16 v[20:23], v[204:207], v[16:19], v[20:23]
    v_mov_b32 v7, v4
    v_mov_b32 v37, 0
    s_nop 5
    v_fmac_f32_dpp v7, v20, v6 quad_perm:[0,0,0,0] row_mask:0xf bank_mask:0xf
    v_fmac_f32_dpp v37, v21, v6 quad_perm:[1,1,1,1] row_mask:0xf bank_mask:0xf
    s_nop 0
    v_fmac_f32_dpp v7, v22, v6 quad_perm:[2,2,2,2] row_mask:0xf bank_mask:0xf
    v_fmac_f32_dpp v37, v23, v6 quad_perm:[3,3,3,3] row_mask:0xf bank_mask:0xf
    v_add_f32 v7, v7, v37
    v_cmp_lt_f32 vcc, 0x41000000, v7
    s_cbranch_vccnz L_stube1_2
L_rese1_2:
    v_exp_f32 v7, v7
    s_nop 0
    v_cvt_pk_bf16_f32 v36, v7, v7
    v_add_f32 v5, v5, v7
    v_and_b32 v24, v36, v8
    v_and_b32 v25, v36, v9
    v_and_b32 v26, v36, v10
    v_and_b32 v27, v36, v11
    s_waitcnt vmcnt(4)
    s_nop 0
    v_mfma_f32_16x16x32_bf16 v[28:31], v[24:27], v[208:211], v[28:31]
    v_mfma_f32_16x16x32_bf16 v[32:35], v[24:27], v[212:215], v[32:35]
    s_waitcnt vmcnt(2)
    v_mfma_f32_16x16x32_bf16 v[20:23], v[216:219], v[12:15], 0
    v_mfma_f32_16x16x32_bf16 v[20:23], v[220:223], v[16:19], v[20:23]
    v_mov_b32 v7, v4
    v_mov_b32 v37, 0
    s_nop 5
    v_fmac_f32_dpp v7, v20, v6 quad_perm:[0,0,0,0] row_mask:0xf bank_mask:0xf
    v_fmac_f32_dpp v37, v21, v6 quad_perm:[1,1,1,1] row_mask:0xf bank_mask:0xf
    s_nop 0
    v_fmac_f32_dpp v7, v22, v6 quad_perm:[2,2,2,2] row_mask:0xf bank_mask:0xf
    v_fmac_f32_dpp v37, v23, v6 quad_perm:[3,3,3,3] row_mask:0xf bank_mask:0xf
    v_add_f32 v7, v7, v37
    v_cmp_lt_f32 vcc, 0x41000000, v7
    s_cbranch_vccnz L_stube1_1
L_rese1_1:
    v_exp_f32 v7, v7
    s_nop 0
    v_cvt_pk_bf16_f32 v36, v7, v7
    v_add_f32 v5, v5, v7
    v_and_b32 v24, v36, v8
    v_and_b32 v25, v36, v9
    v_and_b32 v26, v36, v10
    v_and_b32 v27, v36, v11
    s_waitcnt vmcnt(0)
    s_nop 0
    v_mfma_f32_16x16x32_bf16 v[28:31], v[24:27], v[224:227], v[28:31]
    v_mfma_f32_16x16x32_bf16 v[32:35], v[24:27], v[228:231], v[32:35]
    s_branch L_sdone
    s_nop 6
L_drain2:
    v_mov_b32 v38, 1
    ds_write_b32 v0, v38 offset:10508
    s_waitcnt vmcnt(6)
    v_mfma_f32_16x16x32_bf16 v[20:23], v[216:219], v[12:15], 0
    v_mfma_f32_16x16x32_bf16 v[20:23], v[220:223], v[16:19], v[20:23]
    v_mov_b32 v7, v4
    v_mov_b32 v37, 0
    s_nop 5
    v_fmac_f32_dpp v7, v20, v6 quad_perm:[0,0,0,0] row_mask:0xf bank_mask:0xf
    v_fmac_f32_dpp v37, v21, v6 quad_perm:[1,1,1,1] row_mask:0xf bank_mask:0xf
    s_nop 0
    v_fmac_f32_dpp v7, v22, v6 quad_perm:[2,2,2,2] row_mask:0xf bank_mask:0xf
    v_fmac_f32_dpp v37, v23, v6 quad_perm:[3,3,3,3] row_mask:0xf bank_mask:0xf
    v_add_f32 v7, v7, v37
    v_cmp_lt_f32 vcc, 0x41000000, v7
    s_cbranch_vccnz L_stube2_2
L_rese2_2:
    v_exp_f32 v7, v7
    s_nop 0
    v_cvt_pk_bf16_f32 v36, v7, v7
    v_add_f32 v5, v5, v7
    v_and_b32 v24, v36, v8
    v_and_b32 v25, v36, v9
    v_and_b32 v26, v36, v10
    v_and_b32 v27, v36, v11
    s_waitcnt vmcnt(4)
    s_nop 0
    v_mfma_f32_16x16x32_bf16 v[28:31], v[24:27], v[224:227], v[28:31]
    v_mfma_f32_16x16x32_bf16 v[32:35], v[24:27], v[228:231], v[32:35]
    s_waitcnt vmcnt(2)
    v_mfma_f32_16x16x32_bf16 v[20:23], v[184:187], v[12:15], 0
    v_mfma_f32_16x16x32_bf16 v[20:23], v[188:191], v[16:19], v[20:23]
    v_mov_b32 v7, v4
    v_mov_b32 v37, 0
    s_nop 5
    v_fmac_f32_dpp v7, v20, v6 quad_perm:[0,0,0,0] row_mask:0xf bank_mask:0xf
    v_fmac_f32_dpp v37, v21, v6 quad_perm:[1,1,1,1] row_mask:0xf bank_mask:0xf
    s_nop 0
    v_fmac_f32_dpp v7, v22, v6 quad_perm:[2,2,2,2] row_mask:0xf bank_mask:0xf
    v_fmac_f32_dpp v37, v23, v6 quad_perm:[3,3,3,3] row_mask:0xf bank_mask:0xf
    v_add_f32 v7, v7, v37
    v_cmp_lt_f32 vcc, 0x41000000, v7
    s_cbranch_vccnz L_stube2_1
L_rese2_1:
    v_exp_f32 v7, v7
    s_nop 0
    v_cvt_pk_bf16_f32 v36, v7, v7
    v_add_f32 v5, v5, v7
    v_and_b32 v24, v36, v8
    v_and_b32 v25, v36, v9
    v_and_b32 v26, v36, v10
    v_and_b32 v27, v36, v11
    s_waitcnt vmcnt(0)
    s_nop 0
    v_mfma_f32_16x16x32_bf16 v[28:31], v[24:27], v[192:195], v[28:31]
    v_mfma_f32_16x16x32_bf16 v[32:35], v[24:27], v[196:199], v[32:35]
    s_branch L_sdone
    s_nop 6
L_sdone:
    v_mov_b32 v37, v5
    s_nop 1
    v_permlane16_swap_b32 v5, v37
    s_nop 0
    v_add_f32 v5, v5, v37
    v_mov_b32 v37, v5
    s_nop 1
    v_permlane32_swap_b32 v5, v37
    s_nop 0
    v_add_f32 v5, v5, v37
    v_sub_f32 v38, 0, v4
    ds_write_b128 v249, v[28:31] offset:2048
    ds_write_b128 v249, v[32:35] offset:2560
    s_mov_b32 exec_lo, 0x101
    s_mov_b32 exec_hi, 0
    ds_write_b32 v248, v38 offset:10240
    ds_write_b32 v248, v5 offset:10272
    v_mov_b32 v37, 1
    s_mov_b64 exec, 1
    ds_add_u32 v0, v37 offset:11780
    s_mov_b64 exec, -1
    s_mov_b32 s62, 200000
L_b2:
    ds_read_b32 v38, v0 offset:11780
    s_waitcnt lgkmcnt(0)
    v_cmp_gt_u32 vcc, 4, v38
    s_cbranch_vccz L_b2_ok
    s_sub_u32 s62, s62, 1
    s_cmp_lg_u32 s62, 0
    s_cbranch_scc1 L_b2
L_b2_ok:
    ds_read_b128 v[8:11], v251 offset:10240
    ds_read_b128 v[12:15], v251 offset:10272
    ds_read_b64 v[16:17], v250 offset:2048
    ds_read_b64 v[18:19], v250 offset:4096
    ds_read_b64 v[20:21], v250 offset:6144
    ds_read_b64 v[22:23], v250 offset:8192
    v_mov_b32 v31, s6
    s_mov_b32 s56, 0xaaaaaaaa
    s_mov_b32 s57, 0xaaaaaaaa
    s_waitcnt lgkmcnt(4)
    v_max3_f32 v24, v8, v9, v10
    v_max_f32 v24, v24, v11
    v_sub_f32 v8, v8, v24
    v_sub_f32 v9, v9, v24
    v_sub_f32 v10, v10, v24
    v_sub_f32 v11, v11, v24
    v_exp_f32 v8, v8
    v_exp_f32 v9, v9
    v_exp_f32 v10, v10
    v_exp_f32 v11, v11
    s_waitcnt lgkmcnt(0)
    v_mul_f32 v26, v8, v12
    v_mul_f32 v28, v8, v16
    v_mul_f32 v29, v8, v17
    v_fmac_f32 v26, v9, v13
    v_fmac_f32 v28, v9, v18
    v_fmac_f32 v29, v9, v19
    v_fmac_f32 v26, v10, v14
    v_fmac_f32 v28, v10, v20
    v_fmac_f32 v29, v10, v21
    v_fmac_f32 v26, v11, v15
    v_fmac_f32 v28, v11, v22
    v_fmac_f32 v29, v11, v23
    v_cndmask_b32 v30, v24, v26, s[56:57]
    buffer_store_dwordx4 v[28:31], v252, s[40:43], 0 offen sc1
    s_cmp_ge_u32 s2, 28
    s_cbranch_scc1 L_st_end
    s_mov_b32 s32, s8
    s_mov_b32 s33, s9
    s_mov_b32 s34, 896
    s_mov_b32 s35, 0x20000
    s_mov_b32 s36, s26
    s_mov_b32 s37, s27
    s_mov_b32 s38, 896
    s_mov_b32 s39, 0x20000
    s_lshl_b32 s54, s2, 5
    v_and_b32 v2, 7, v1
    v_lshlrev_b32 v7, 3, v2
    v_lshlrev_b32 v2, 2, v2
    v_add_u32 v2, s54, v2
    buffer_load_dword v4, v2, s[32:35], 0 offen
    s_lshl_b32 s54, s2, 15
    s_mul_i32 s55, s3, 7168
    s_add_u32 s55, s55, s54
    s_add_u32 s55, s55, 524288
    v_lshlrev_b32 v3, 4, v1
    v_add_u32 v3, s55, v3
    v_add_u32 v6, 4096, v3
    s_lshl_b32 s54, s3, 6
    v_add_u32 v5, s54, v7
    s_barrier
    s_mov_b32 s62, 200000
L_py:
    buffer_load_dwordx4 v[64:67], v3, s[40:43], 0 offen offset:0 sc1
    buffer_load_dwordx4 v[68:71], v3, s[40:43], 0 offen offset:1024 sc1
    buffer_load_dwordx4 v[72:75], v3, s[40:43], 0 offen offset:2048 sc1
    buffer_load_dwordx4 v[76:79], v3, s[40:43], 0 offen offset:3072 sc1
    buffer_load_dwordx4 v[80:83], v6, s[40:43], 0 offen offset:0 sc1
    buffer_load_dwordx4 v[84:87], v6, s[40:43], 0 offen offset:1024 sc1
    buffer_load_dwordx4 v[88:91], v6, s[40:43], 0 offen offset:2048 sc1
    s_mov_b64 exec, -1
    s_waitcnt vmcnt(0)
    v_xor_b32 v9, s6, v65
    v_bitop3_b32 v9, v67, s6, v9 bitop3:0xbe
    v_bitop3_b32 v9, v69, s6, v9 bitop3:0xbe
    v_bitop3_b32 v9, v71, s6, v9 bitop3:0xbe
    v_bitop3_b32 v9, v73, s6, v9 bitop3:0xbe
    v_bitop3_b32 v9, v75, s6, v9 bitop3:0xbe
    v_bitop3_b32 v9, v77, s6, v9 bitop3:0xbe
    v_bitop3_b32 v9, v79, s6, v9 bitop3:0xbe
    v_bitop3_b32 v9, v81, s6, v9 bitop3:0xbe
    v_bitop3_b32 v9, v83, s6, v9 bitop3:0xbe
    v_bitop3_b32 v9, v85, s6, v9 bitop3:0xbe
    v_bitop3_b32 v9, v87, s6, v9 bitop3:0xbe
    v_bitop3_b32 v9, v89, s6, v9 bitop3:0xbe
    v_bitop3_b32 v9, v91, s6, v9 bitop3:0xbe
    v_cmp_ne_u32 vcc, 0, v9
    s_cbranch_vccz L_py_ok
    s_sleep 1
    s_sub_u32 s62, s62, 1
    s_cmp_lg_u32 s62, 0
    s_cbranch_scc1 L_py
L_py_ok:
    v_add_f32 v10, v64, v68
    v_add_f32 v11, v66, v70
    v_add_f32 v12, v72, v76
    v_add_f32 v13, v74, v78
    v_add_f32 v14, v80, v84
    v_add_f32 v15, v82, v86
    v_mov_b32 v16, v88
    v_mov_b32 v17, v90
    v_add_f32 v10, v10, v12
    v_add_f32 v11, v11, v13
    v_add_f32 v14, v14, v16
    v_add_f32 v15, v15, v17
    v_add_f32 v10, v10, v14
    v_add_f32 v11, v11, v15
    s_nop 0
    v_add_f32_dpp v10, v10, v10 row_ror:8 row_mask:0xf bank_mask:0xf
    v_add_f32_dpp v11, v11, v11 row_ror:8 row_mask:0xf bank_mask:0xf
    v_mov_b32 v12, v10
    v_mov_b32 v13, v11
    s_nop 0
    v_permlane16_swap_b32 v10, v12
    v_permlane16_swap_b32 v11, v13
    v_add_f32 v10, v10, v12
    v_add_f32 v11, v11, v13
    v_mov_b32 v12, v10
    v_mov_b32 v13, v11
    s_nop 0
    v_permlane32_swap_b32 v10, v12
    v_permlane32_swap_b32 v11, v13
    v_add_f32 v10, v10, v12
    v_add_f32 v11, v11, v13
    s_mov_b64 exec, 0xff
    ds_write_b64 v5, v[10:11] offset:10752
    s_mov_b64 exec, -1
    s_waitcnt lgkmcnt(0)
    s_lshl_b32 s54, s2, 15
    s_lshl_b32 s55, s3, 13
    s_add_u32 s55, s55, s54
    s_add_u32 s55, s55, 2621440
    v_lshlrev_b32 v3, 4, v1
    v_add_u32 v3, s55, v3
    v_add_u32 v6, 4096, v3
    v_lshlrev_b32 v24, 16, v4
    v_and_b32 v25, 0xffff0000, v4
    s_barrier
    ds_read_b64 v[12:13], v7 offset:10752
    ds_read_b64 v[14:15], v7 offset:10816
    ds_read_b64 v[16:17], v7 offset:10880
    ds_read_b64 v[18:19], v7 offset:10944
    s_waitcnt lgkmcnt(0)
    v_add_f32 v10, v12, v14
    v_add_f32 v11, v13, v15
    v_add_f32 v16, v16, v18
    v_add_f32 v17, v17, v19
    v_add_f32 v10, v10, v16
    v_add_f32 v11, v11, v17
    v_cvt_pk_bf16_f32 v20, v10, 0
    v_lshlrev_b32 v20, 16, v20
    v_cvt_pk_bf16_f32 v21, v11, 0
    v_lshlrev_b32 v21, 16, v21
    v_mul_f32 v22, 0xbfb8aa3b, v20
    v_mul_f32 v23, 0xbfb8aa3b, v21
    v_exp_f32 v22, v22
    v_exp_f32 v23, v23
    v_add_f32 v22, 1.0, v22
    v_add_f32 v23, 1.0, v23
    v_rcp_f32 v22, v22
    v_rcp_f32 v23, v23
    v_mul_f32 v20, v20, v22
    v_mul_f32 v21, v21, v23
    v_cvt_pk_bf16_f32 v20, v20, 0
    v_lshlrev_b32 v20, 16, v20
    v_cvt_pk_bf16_f32 v21, v21, 0
    v_lshlrev_b32 v21, 16, v21
    s_mov_b32 s62, 200000
    s_nop 0
L_ps:
    buffer_load_dwordx4 v[64:67], v3, s[40:43], 0 offen offset:0 sc1
    buffer_load_dwordx4 v[68:71], v3, s[40:43], 0 offen offset:1024 sc1
    buffer_load_dwordx4 v[72:75], v3, s[40:43], 0 offen offset:2048 sc1
    buffer_load_dwordx4 v[76:79], v3, s[40:43], 0 offen offset:3072 sc1
    buffer_load_dwordx4 v[80:83], v6, s[40:43], 0 offen offset:0 sc1
    buffer_load_dwordx4 v[84:87], v6, s[40:43], 0 offen offset:1024 sc1
    buffer_load_dwordx4 v[88:91], v6, s[40:43], 0 offen offset:2048 sc1
    buffer_load_dwordx4 v[92:95], v6, s[40:43], 0 offen offset:3072 sc1
    s_mov_b64 exec, -1
    s_waitcnt vmcnt(0)
    v_xor_b32 v9, s6, v65
    v_bitop3_b32 v9, v67, s6, v9 bitop3:0xbe
    v_bitop3_b32 v9, v69, s6, v9 bitop3:0xbe
    v_bitop3_b32 v9, v71, s6, v9 bitop3:0xbe
    v_bitop3_b32 v9, v73, s6, v9 bitop3:0xbe
    v_bitop3_b32 v9, v75, s6, v9 bitop3:0xbe
    v_bitop3_b32 v9, v77, s6, v9 bitop3:0xbe
    v_bitop3_b32 v9, v79, s6, v9 bitop3:0xbe
    v_bitop3_b32 v9, v81, s6, v9 bitop3:0xbe
    v_bitop3_b32 v9, v83, s6, v9 bitop3:0xbe
    v_bitop3_b32 v9, v85, s6, v9 bitop3:0xbe
    v_bitop3_b32 v9, v87, s6, v9 bitop3:0xbe
    v_bitop3_b32 v9, v89, s6, v9 bitop3:0xbe
    v_bitop3_b32 v9, v91, s6, v9 bitop3:0xbe
    v_bitop3_b32 v9, v93, s6, v9 bitop3:0xbe
    v_bitop3_b32 v9, v95, s6, v9 bitop3:0xbe
    v_cmp_ne_u32 vcc, 0, v9
    s_cbranch_vccz L_ps_ok
    s_sleep 6
    s_sub_u32 s62, s62, 1
    s_cmp_lg_u32 s62, 0
    s_cbranch_scc1 L_ps
L_ps_ok:
    v_add_f32 v10, v64, v68
    v_add_f32 v11, v66, v70
    v_add_f32 v12, v72, v76
    v_add_f32 v13, v74, v78
    v_add_f32 v14, v80, v84
    v_add_f32 v15, v82, v86
    v_add_f32 v16, v88, v92
    v_add_f32 v17, v90, v94
    v_add_f32 v10, v10, v12
    v_add_f32 v11, v11, v13
    v_add_f32 v14, v14, v16
    v_add_f32 v15, v15, v17
    v_add_f32 v10, v10, v14
    v_add_f32 v11, v11, v15
    s_nop 0
    v_add_f32_dpp v10, v10, v10 row_ror:8 row_mask:0xf bank_mask:0xf
    v_add_f32_dpp v11, v11, v11 row_ror:8 row_mask:0xf bank_mask:0xf
    v_mov_b32 v12, v10
    v_mov_b32 v13, v11
    s_nop 0
    v_permlane16_swap_b32 v10, v12
    v_permlane16_swap_b32 v11, v13
    v_add_f32 v10, v10, v12
    v_add_f32 v11, v11, v13
    v_mov_b32 v12, v10
    v_mov_b32 v13, v11
    s_nop 0
    v_permlane32_swap_b32 v10, v12
    v_permlane32_swap_b32 v11, v13
    v_add_f32 v10, v10, v12
    v_add_f32 v11, v11, v13
    s_mov_b64 exec, 0xff
    ds_write_b64 v5, v[10:11] offset:11008
    s_mov_b64 exec, -1
    s_waitcnt lgkmcnt(0)
    s_barrier
    s_cmp_lg_u32 s3, 0
    s_cbranch_scc1 L_fin_done
    ds_read_b64 v[12:13], v7 offset:11008
    ds_read_b64 v[14:15], v7 offset:11072
    ds_read_b64 v[16:17], v7 offset:11136
    ds_read_b64 v[18:19], v7 offset:11200
    s_waitcnt lgkmcnt(0)
    v_add_f32 v10, v12, v14
    v_add_f32 v11, v13, v15
    v_add_f32 v16, v16, v18
    v_add_f32 v17, v17, v19
    v_add_f32 v10, v10, v16
    v_add_f32 v11, v11, v17
    v_cvt_pk_bf16_f32 v10, v10, 0
    v_lshlrev_b32 v10, 16, v10
    v_cvt_pk_bf16_f32 v11, v11, 0
    v_lshlrev_b32 v11, 16, v11
    v_mul_f32 v10, v10, v20
    v_mul_f32 v11, v11, v21
    v_cvt_pk_bf16_f32 v10, v10, 0
    v_lshlrev_b32 v10, 16, v10
    v_cvt_pk_bf16_f32 v11, v11, 0
    v_lshlrev_b32 v11, 16, v11
    v_add_f32 v10, v10, v24
    v_add_f32 v11, v11, v25
    v_cvt_pk_bf16_f32 v14, v10, v11
    s_mov_b64 exec, 0xff
    buffer_store_dword v14, v2, s[36:39], 0 offen
    s_cmp_lg_u32 s2, 0
    s_cbranch_scc1 L_fin_x
    s_mov_b64 exec, 1
    v_mov_b32 v16, 0
    v_mov_b32 v17, s6
    buffer_store_dword v17, v16, s[40:43], 0 offen
    s_nop 0
L_fin_x:
    s_mov_b64 exec, -1
L_fin_done:
L_st_end:
    s_endpgm
L_stub1:
    s_call_b64 s[52:53], L_rare
    s_branch L_res1
L_stub2:
    s_call_b64 s[52:53], L_rare
    s_branch L_res2
L_stub3:
    s_call_b64 s[52:53], L_rare
    s_branch L_res3
L_stub4:
    s_call_b64 s[52:53], L_rare
    s_branch L_res4
L_stub5:
    s_call_b64 s[52:53], L_rare
    s_branch L_res5
L_stub6:
    s_call_b64 s[52:53], L_rare
    s_branch L_res6
L_stub7:
    s_call_b64 s[52:53], L_rare
    s_branch L_res7
L_stub8:
    s_call_b64 s[52:53], L_rare
    s_branch L_res8
L_stub9:
    s_call_b64 s[52:53], L_rare
    s_branch L_res9
L_stub10:
    s_call_b64 s[52:53], L_rare
    s_branch L_res10
L_stub11:
    s_call_b64 s[52:53], L_rare
    s_branch L_res11
L_stub12:
    s_call_b64 s[52:53], L_rare
    s_branch L_res12
L_stub13:
    s_call_b64 s[52:53], L_rare
    s_branch L_res13
L_stub14:
    s_call_b64 s[52:53], L_rare
    s_branch L_res14
L_stub15:
    s_call_b64 s[52:53], L_rare
    s_branch L_res15
L_stub16:
    s_call_b64 s[52:53], L_rare
    s_branch L_res16
L_stub17:
    s_call_b64 s[52:53], L_rare
    s_branch L_res17
L_stub18:
    s_call_b64 s[52:53], L_rare
    s_branch L_res18
L_stub19:
    s_call_b64 s[52:53], L_rare
    s_branch L_res19
L_stub20:
    s_call_b64 s[52:53], L_rare
    s_branch L_res20
L_stub21:
    s_call_b64 s[52:53], L_rare
    s_branch L_res21
L_stubd0:
    s_call_b64 s[52:53], L_rare
    s_branch L_resd0
L_stubd1:
    s_call_b64 s[52:53], L_rare
    s_branch L_resd1
L_stubd2:
    s_call_b64 s[52:53], L_rare
    s_branch L_resd2
L_stube0_2:
    s_call_b64 s[52:53], L_rare
    s_branch L_rese0_2
L_stube0_1:
    s_call_b64 s[52:53], L_rare
    s_branch L_rese0_1
L_stube1_2:
    s_call_b64 s[52:53], L_rare
    s_branch L_rese1_2
L_stube1_1:
    s_call_b64 s[52:53], L_rare
    s_branch L_rese1_1
L_stube2_2:
    s_call_b64 s[52:53], L_rare
    s_branch L_rese2_2
L_stube2_1:
    s_call_b64 s[52:53], L_rare
    s_branch L_rese2_1
L_rare:
    s_nop 7
    v_mov_b32 v37, v7
    v_mov_b32 v38, v37
    s_nop 1
    v_permlane16_swap_b32 v37, v38
    s_nop 0
    v_max_f32 v37, v37, v38
    v_mov_b32 v38, v37
    s_nop 1
    v_permlane32_swap_b32 v37, v38
    s_nop 0
    v_max_f32 v37, v37, v38
    v_max_f32 v37, 0, v37
    v_sub_f32 v4, v4, v37
    v_sub_f32 v7, v7, v37
    v_sub_f32 v38, 0, v37
    v_exp_f32 v38, v38
    s_nop 0
    v_mul_f32 v5, v5, v38
    v_readlane_b32 s54, v38, 0
    v_readlane_b32 s55, v38, 8
    s_nop 0
    v_mov_b32 v39, s54
    v_mov_b32 v37, s55
    s_mov_b32 s56, 0
    s_mov_b32 s57, -1
    v_cndmask_b32 v39, v39, v37, s[56:57]
    v_mul_f32 v28, v28, v39
    v_mul_f32 v29, v29, v39
    v_mul_f32 v30, v30, v39
    v_mul_f32 v31, v31, v39
    v_mul_f32 v32, v32, v39
    v_mul_f32 v33, v33, v39
    v_mul_f32 v34, v34, v39
    v_mul_f32 v35, v35, v39
    s_nop 1
    s_setpc_b64 s[52:53]
L_helpers:
    s_waitcnt lgkmcnt(0)
    s_load_dword s6, s[30:31], 0
    s_cmp_eq_u32 s3, 5
    s_cbranch_scc1 L_h1
    s_cmp_eq_u32 s3, 6
    s_cbranch_scc1 L_h2
L_h0:
    s_mov_b32 s32, s8
    s_mov_b32 s33, s9
    s_mov_b32 s34, 896
    s_mov_b32 s35, 0x20000
    s_mov_b32 s36, s14
    s_mov_b32 s37, s15
    s_mov_b32 s38, 3670016
    s_mov_b32 s39, 0x20000
    s_mov_b32 s40, s30
    s_mov_b32 s41, s31
    s_mov_b32 s42, 4194304
    s_mov_b32 s43, 0x20000
    v_lshlrev_b32 v2, 4, v1
    buffer_load_dwordx4 v[4:7], v2, s[32:35], 0 offen
    s_and_b32 s54, s2, 31
    s_cmp_lg_u32 s54, 0
    s_cbranch_scc1 L_h0_noinit
    s_lshl_b32 s54, s2, 5
    s_add_u32 s54, s54, 65536
    v_mov_b32 v8, s54
    v_mov_b32 v9, 0
    s_mov_b64 exec, 1
    buffer_store_dword v9, v8, s[40:43], 0 offen sc1
    s_mov_b64 exec, -1
L_h0_noinit:
    s_and_b32 s54, s5, 7
    s_lshr_b32 s59, s5, 3
    s_lshl_b32 s55, s4, 10
    s_lshl_b32 s56, s54, 7
    s_add_u32 s55, s55, s56
    s_mul_i32 s56, s59, 917504
    s_add_u32 s55, s55, s56
    v_lshrrev_b32 v3, 3, v1
    v_lshlrev_b32 v3, 13, v3
    v_and_b32 v8, 7, v1
    v_lshlrev_b32 v8, 4, v8
    v_add3_u32 v3, v3, v8, s55
    s_mov_b32 s57, 0
    buffer_load_dwordx4 v[64:67], v3, s[36:39], s57 offen nt
    s_mov_b32 s57, 65536
    buffer_load_dwordx4 v[68:71], v3, s[36:39], s57 offen nt
    s_mov_b32 s57, 131072
    buffer_load_dwordx4 v[72:75], v3, s[36:39], s57 offen nt
    s_mov_b32 s57, 196608
    buffer_load_dwordx4 v[76:79], v3, s[36:39], s57 offen nt
    s_mov_b32 s57, 262144
    buffer_load_dwordx4 v[80:83], v3, s[36:39], s57 offen nt
    s_mov_b32 s57, 327680
    buffer_load_dwordx4 v[84:87], v3, s[36:39], s57 offen nt
    s_mov_b32 s57, 393216
    buffer_load_dwordx4 v[88:91], v3, s[36:39], s57 offen nt
    s_mov_b32 s57, 458752
    buffer_load_dwordx4 v[92:95], v3, s[36:39], s57 offen nt
    s_mov_b32 s57, 524288
    buffer_load_dwordx4 v[96:99], v3, s[36:39], s57 offen nt
    s_mov_b32 s57, 589824
    buffer_load_dwordx4 v[100:103], v3, s[36:39], s57 offen nt
    s_mov_b32 s57, 655360
    buffer_load_dwordx4 v[104:107], v3, s[36:39], s57 offen nt
    s_mov_b32 s57, 720896
    buffer_load_dwordx4 v[108:111], v3, s[36:39], s57 offen nt
    s_mov_b32 s57, 786432
    buffer_load_dwordx4 v[112:115], v3, s[36:39], s57 offen nt
    s_mov_b32 s57, 851968
    buffer_load_dwordx4 v[116:119], v3, s[36:39], s57 offen nt
    s_barrier
    s_waitcnt vmcnt(14)
    v_lshlrev_b32 v10, 16, v4
    v_and_b32 v11, 0xffff0000, v4
    v_lshlrev_b32 v12, 16, v5
    v_and_b32 v13, 0xffff0000, v5
    v_lshlrev_b32 v14, 16, v6
    v_and_b32 v15, 0xffff0000, v6
    v_lshlrev_b32 v16, 16, v7
    v_and_b32 v17, 0xffff0000, v7
    v_add_f32 v18, v10, v11
    v_add_f32 v19, v12, v13
    v_add_f32 v20, v14, v15
    v_add_f32 v21, v16, v17
    v_add_f32 v18, v18, v19
    v_add_f32 v20, v20, v21
    v_add_f32 v18, v18, v20
    s_nop 1
    v_add_f32_dpp v18, v18, v18 row_ror:8 row_mask:0xf bank_mask:0xf
    s_nop 1
    v_add_f32_dpp v18, v18, v18 row_ror:4 row_mask:0xf bank_mask:0xf
    s_nop 1
    v_add_f32_dpp v18, v18, v18 row_ror:2 row_mask:0xf bank_mask:0xf
    s_nop 1
    v_add_f32_dpp v18, v18, v18 row_ror:1 row_mask:0xf bank_mask:0xf
    v_mov_b32 v19, v18
    s_nop 1
    v_permlane16_swap_b32 v18, v19
    s_nop 0
    v_add_f32 v18, v18, v19
    v_mov_b32 v19, v18
    s_nop 1
    v_permlane32_swap_b32 v18, v19
    s_nop 0
    v_add_f32 v18, v18, v19
    v_mul_f32 v18, 0x3b124925, v18
    v_sub_f32 v20, v10, v18
    v_sub_f32 v21, v11, v18
    v_sub_f32 v22, v12, v18
    v_sub_f32 v23, v13, v18
    v_sub_f32 v24, v14, v18
    v_sub_f32 v25, v15, v18
    v_sub_f32 v26, v16, v18
    v_sub_f32 v27, v17, v18
    v_mul_f32 v19, v20, v20
    v_fmac_f32 v19, v21, v21
    v_fmac_f32 v19, v22, v22
    v_fmac_f32 v19, v23, v23
    v_fmac_f32 v19, v24, v24
    v_fmac_f32 v19, v25, v25
    v_fmac_f32 v19, v26, v26
    v_fmac_f32 v19, v27, v27
    v_cmp_gt_u32 vcc, 56, v1
    s_nop 1
    v_cndmask_b32 v19, 0, v19, vcc
    s_nop 1
    v_add_f32_dpp v19, v19, v19 row_ror:8 row_mask:0xf bank_mask:0xf
    s_nop 1
    v_add_f32_dpp v19, v19, v19 row_ror:4 row_mask:0xf bank_mask:0xf
    s_nop 1
    v_add_f32_dpp v19, v19, v19 row_ror:2 row_mask:0xf bank_mask:0xf
    s_nop 1
    v_add_f32_dpp v19, v19, v19 row_ror:1 row_mask:0xf bank_mask:0xf
    v_mov_b32 v20, v19
    s_nop 1
    v_permlane16_swap_b32 v19, v20
    s_nop 0
    v_add_f32 v19, v19, v20
    v_mov_b32 v20, v19
    s_nop 1
    v_permlane32_swap_b32 v19, v20
    s_nop 0
    v_add_f32 v19, v19, v20
    v_mul_f32 v19, 0x3b124925, v19
    v_cvt_pk_bf16_f32 v18, v18, 0
    v_lshlrev_b32 v18, 16, v18
    v_cvt_pk_bf16_f32 v19, v19, 0
    v_lshlrev_b32 v19, 16, v19
    v_add_f32 v19, 0x3727c5ac, v19
    v_cvt_pk_bf16_f32 v19, v19, 0
    v_lshlrev_b32 v19, 16, v19
    v_sqrt_f32 v19, v19
    s_nop 0
    v_cvt_pk_bf16_f32 v19, v19, 0
    v_lshlrev_b32 v19, 16, v19
    v_rcp_f32 v8, v19
    v_sub_f32 v20, v10, v18
    v_sub_f32 v21, v11, v18
    v_sub_f32 v22, v12, v18
    v_sub_f32 v23, v13, v18
    v_sub_f32 v24, v14, v18
    v_sub_f32 v25, v15, v18
    v_sub_f32 v26, v16, v18
    v_sub_f32 v27, v17, v18
    v_cvt_pk_bf16_f32 v20, v20, 0
    v_cvt_pk_bf16_f32 v21, v21, 0
    v_cvt_pk_bf16_f32 v22, v22, 0
    v_cvt_pk_bf16_f32 v23, v23, 0
    v_cvt_pk_bf16_f32 v24, v24, 0
    v_cvt_pk_bf16_f32 v25, v25, 0
    v_cvt_pk_bf16_f32 v26, v26, 0
    v_cvt_pk_bf16_f32 v27, v27, 0
    v_lshlrev_b32 v20, 16, v20
    v_lshlrev_b32 v21, 16, v21
    v_lshlrev_b32 v22, 16, v22
    v_lshlrev_b32 v23, 16, v23
    v_lshlrev_b32 v24, 16, v24
    v_lshlrev_b32 v25, 16, v25
    v_lshlrev_b32 v26, 16, v26
    v_lshlrev_b32 v27, 16, v27
    v_mul_f32 v10, v20, v8
    v_mul_f32 v11, v21, v8
    v_mul_f32 v12, v22, v8
    v_mul_f32 v13, v23, v8
    v_mul_f32 v14, v24, v8
    v_mul_f32 v15, v25, v8
    v_mul_f32 v16, v26, v8
    v_mul_f32 v17, v27, v8
    v_fma_f32 v20, -v10, v19, v20
    v_fma_f32 v21, -v11, v19, v21
    v_fma_f32 v22, -v12, v19, v22
    v_fma_f32 v23, -v13, v19, v23
    v_fma_f32 v24, -v14, v19, v24
    v_fma_f32 v25, -v15, v19, v25
    v_fma_f32 v26, -v16, v19, v26
    v_fma_f32 v27, -v17, v19, v27
    v_fmac_f32 v10, v20, v8
    v_fmac_f32 v11, v21, v8
    v_fmac_f32 v12, v22, v8
    v_fmac_f32 v13, v23, v8
    v_fmac_f32 v14, v24, v8
    v_fmac_f32 v15, v25, v8
    v_fmac_f32 v16, v26, v8
    v_fmac_f32 v17, v27, v8
    v_cvt_pk_bf16_f32 v20, v10, 0
    v_cvt_pk_bf16_f32 v21, v11, 0
    v_cvt_pk_bf16_f32 v22, v12, 0
    v_cvt_pk_bf16_f32 v23, v13, 0
    v_cvt_pk_bf16_f32 v24, v14, 0
    v_cvt_pk_bf16_f32 v25, v15, 0
    v_cvt_pk_bf16_f32 v26, v16, 0
    v_cvt_pk_bf16_f32 v27, v17, 0
    v_lshlrev_b32 v9, 5, v1
    ds_write_b128 v9, v[20:23] offset:12288
    ds_write_b128 v9, v[24:27] offset:12304
    s_waitcnt lgkmcnt(0)
    s_mul_i32 s6, s6, 0x9E3779B1
    s_add_u32 s6, s6, 0x7F4A7C15
    v_mov_b32 v8, 0
    v_mov_b32 v9, 1
    ds_write_b32 v8, v9 offset:10500
    s_mul_i32 s56, s59, 448
    v_lshrrev_b32 v9, 3, v1
    v_lshlrev_b32 v9, 2, v9
    v_add_u32 v9, s56, v9
    ds_read_b32 v32, v9 offset:12288
    ds_read_b32 v33, v9 offset:12320
    ds_read_b32 v34, v9 offset:12352
    ds_read_b32 v35, v9 offset:12384
    ds_read_b32 v36, v9 offset:12416
    ds_read_b32 v37, v9 offset:12448
    ds_read_b32 v38, v9 offset:12480
    ds_read_b32 v39, v9 offset:12512
    ds_read_b32 v40, v9 offset:12544
    ds_read_b32 v41, v9 offset:12576
    ds_read_b32 v42, v9 offset:12608
    ds_read_b32 v43, v9 offset:12640
    ds_read_b32 v44, v9 offset:12672
    ds_read_b32 v45, v9 offset:12704
    v_mov_b32 v10, 0
    v_mov_b32 v11, 0
    v_mov_b32 v12, 0
    v_mov_b32 v13, 0
    v_mov_b32 v14, 0
    v_mov_b32 v15, 0
    v_mov_b32 v16, 0
    v_mov_b32 v17, 0
    s_lshl_b32 s55, s4, 14
    s_lshl_b32 s56, s59, 12
    s_add_u32 s55, s55, s56
    s_lshl_b32 s56, s54, 9
    s_add_u32 s55, s55, s56
    s_add_u32 s55, s55, 131072
    v_and_b32 v2, 7, v1
    v_lshlrev_b32 v2, 6, v2
    v_lshrrev_b32 v8, 4, v1
    v_lshlrev_b32 v8, 4, v8
    v_add3_u32 v2, v2, v8, s55
    s_waitcnt lgkmcnt(0)
    v_lshlrev_b32 v46, 16, v32
    v_lshlrev_b32 v47, 16, v33
    v_lshlrev_b32 v48, 16, v34
    v_lshlrev_b32 v49, 16, v35
    v_lshlrev_b32 v50, 16, v36
    v_lshlrev_b32 v51, 16, v37
    v_lshlrev_b32 v52, 16, v38
    v_lshlrev_b32 v53, 16, v39
    v_lshlrev_b32 v54, 16, v40
    v_lshlrev_b32 v55, 16, v41
    v_lshlrev_b32 v56, 16, v42
    v_lshlrev_b32 v57, 16, v43
    v_lshlrev_b32 v58, 16, v44
    v_lshlrev_b32 v59, 16, v45
    s_waitcnt vmcnt(13)
    v_dot2c_f32_bf16 v10, v64, v32
    v_dot2c_f32_bf16 v11, v64, v46
    v_dot2c_f32_bf16 v12, v65, v32
    v_dot2c_f32_bf16 v13, v65, v46
    v_dot2c_f32_bf16 v14, v66, v32
    v_dot2c_f32_bf16 v15, v66, v46
    v_dot2c_f32_bf16 v16, v67, v32
    v_dot2c_f32_bf16 v17, v67, v46
    s_waitcnt vmcnt(12)
    v_dot2c_f32_bf16 v10, v68, v33
    v_dot2c_f32_bf16 v11, v68, v47
    v_dot2c_f32_bf16 v12, v69, v33
    v_dot2c_f32_bf16 v13, v69, v47
    v_dot2c_f32_bf16 v14, v70, v33
    v_dot2c_f32_bf16 v15, v70, v47
    v_dot2c_f32_bf16 v16, v71, v33
    v_dot2c_f32_bf16 v17, v71, v47
    s_waitcnt vmcnt(11)
    v_dot2c_f32_bf16 v10, v72, v34
    v_dot2c_f32_bf16 v11, v72, v48
    v_dot2c_f32_bf16 v12, v73, v34
    v_dot2c_f32_bf16 v13, v73, v48
    v_dot2c_f32_bf16 v14, v74, v34
    v_dot2c_f32_bf16 v15, v74, v48
    v_dot2c_f32_bf16 v16, v75, v34
    v_dot2c_f32_bf16 v17, v75, v48
    s_waitcnt vmcnt(10)
    v_dot2c_f32_bf16 v10, v76, v35
    v_dot2c_f32_bf16 v11, v76, v49
    v_dot2c_f32_bf16 v12, v77, v35
    v_dot2c_f32_bf16 v13, v77, v49
    v_dot2c_f32_bf16 v14, v78, v35
    v_dot2c_f32_bf16 v15, v78, v49
    v_dot2c_f32_bf16 v16, v79, v35
    v_dot2c_f32_bf16 v17, v79, v49
    s_waitcnt vmcnt(9)
    v_dot2c_f32_bf16 v10, v80, v36
    v_dot2c_f32_bf16 v11, v80, v50
    v_dot2c_f32_bf16 v12, v81, v36
    v_dot2c_f32_bf16 v13, v81, v50
    v_dot2c_f32_bf16 v14, v82, v36
    v_dot2c_f32_bf16 v15, v82, v50
    v_dot2c_f32_bf16 v16, v83, v36
    v_dot2c_f32_bf16 v17, v83, v50
    s_waitcnt vmcnt(8)
    v_dot2c_f32_bf16 v10, v84, v37
    v_dot2c_f32_bf16 v11, v84, v51
    v_dot2c_f32_bf16 v12, v85, v37
    v_dot2c_f32_bf16 v13, v85, v51
    v_dot2c_f32_bf16 v14, v86, v37
    v_dot2c_f32_bf16 v15, v86, v51
    v_dot2c_f32_bf16 v16, v87, v37
    v_dot2c_f32_bf16 v17, v87, v51
    s_waitcnt vmcnt(7)
    v_dot2c_f32_bf16 v10, v88, v38
    v_dot2c_f32_bf16 v11, v88, v52
    v_dot2c_f32_bf16 v12, v89, v38
    v_dot2c_f32_bf16 v13, v89, v52
    v_dot2c_f32_bf16 v14, v90, v38
    v_dot2c_f32_bf16 v15, v90, v52
    v_dot2c_f32_bf16 v16, v91, v38
    v_dot2c_f32_bf16 v17, v91, v52
    s_waitcnt vmcnt(6)
    v_dot2c_f32_bf16 v10, v92, v39
    v_dot2c_f32_bf16 v11, v92, v53
    v_dot2c_f32_bf16 v12, v93, v39
    v_dot2c_f32_bf16 v13, v93, v53
    v_dot2c_f32_bf16 v14, v94, v39
    v_dot2c_f32_bf16 v15, v94, v53
    v_dot2c_f32_bf16 v16, v95, v39
    v_dot2c_f32_bf16 v17, v95, v53
    s_waitcnt vmcnt(5)
    v_dot2c_f32_bf16 v10, v96, v40
    v_dot2c_f32_bf16 v11, v96, v54
    v_dot2c_f32_bf16 v12, v97, v40
    v_dot2c_f32_bf16 v13, v97, v54
    v_dot2c_f32_bf16 v14, v98, v40
    v_dot2c_f32_bf16 v15, v98, v54
    v_dot2c_f32_bf16 v16, v99, v40
    v_dot2c_f32_bf16 v17, v99, v54
    s_waitcnt vmcnt(4)
    v_dot2c_f32_bf16 v10, v100, v41
    v_dot2c_f32_bf16 v11, v100, v55
    v_dot2c_f32_bf16 v12, v101, v41
    v_dot2c_f32_bf16 v13, v101, v55
    v_dot2c_f32_bf16 v14, v102, v41
    v_dot2c_f32_bf16 v15, v102, v55
    v_dot2c_f32_bf16 v16, v103, v41
    v_dot2c_f32_bf16 v17, v103, v55
    s_waitcnt vmcnt(3)
    v_dot2c_f32_bf16 v10, v104, v42
    v_dot2c_f32_bf16 v11, v104, v56
    v_dot2c_f32_bf16 v12, v105, v42
    v_dot2c_f32_bf16 v13, v105, v56
    v_dot2c_f32_bf16 v14, v106, v42
    v_dot2c_f32_bf16 v15, v106, v56
    v_dot2c_f32_bf16 v16, v107, v42
    v_dot2c_f32_bf16 v17, v107, v56
    s_waitcnt vmcnt(2)
    v_dot2c_f32_bf16 v10, v108, v43
    v_dot2c_f32_bf16 v11, v108, v57
    v_dot2c_f32_bf16 v12, v109, v43
    v_dot2c_f32_bf16 v13, v109, v57
    v_dot2c_f32_bf16 v14, v110, v43
    v_dot2c_f32_bf16 v15, v110, v57
    v_dot2c_f32_bf16 v16, v111, v43
    v_dot2c_f32_bf16 v17, v111, v57
    s_waitcnt vmcnt(1)
    v_dot2c_f32_bf16 v10, v112, v44
    v_dot2c_f32_bf16 v11, v112, v58
    v_dot2c_f32_bf16 v12, v113, v44
    v_dot2c_f32_bf16 v13, v113, v58
    v_dot2c_f32_bf16 v14, v114, v44
    v_dot2c_f32_bf16 v15, v114, v58
    v_dot2c_f32_bf16 v16, v115, v44
    v_dot2c_f32_bf16 v17, v115, v58
    s_waitcnt vmcnt(0)
    v_dot2c_f32_bf16 v10, v116, v45
    v_dot2c_f32_bf16 v11, v116, v59
    v_dot2c_f32_bf16 v12, v117, v45
    v_dot2c_f32_bf16 v13, v117, v59
    v_dot2c_f32_bf16 v14, v118, v45
    v_dot2c_f32_bf16 v15, v118, v59
    v_dot2c_f32_bf16 v16, v119, v45
    v_dot2c_f32_bf16 v17, v119, v59
    v_permlane32_swap_b32 v10, v14
    v_permlane32_swap_b32 v11, v15
    v_permlane32_swap_b32 v12, v16
    v_permlane32_swap_b32 v13, v17
    v_add_f32 v10, v10, v14
    v_add_f32 v11, v11, v15
    v_add_f32 v12, v12, v16
    v_add_f32 v13, v13, v17
    s_nop 0
    v_permlane16_swap_b32 v10, v12
    v_permlane16_swap_b32 v11, v13
    v_add_f32 v10, v10, v12
    v_add_f32 v11, v11, v13
    s_nop 0
    v_add_f32_dpp v10, v10, v10 row_ror:8 row_mask:0xf bank_mask:0xf
    v_add_f32_dpp v11, v11, v11 row_ror:8 row_mask:0xf bank_mask:0xf
    v_mov_b32 v12, v11
    v_mov_b32 v11, s6
    v_mov_b32 v13, s6
    s_mov_b32 exec_lo, 0x00ff00ff
    s_mov_b32 exec_hi, 0x00ff00ff
    buffer_store_dwordx4 v[10:13], v2, s[40:43], 0 offen sc1
    s_mov_b64 exec, -1
    v_mov_b32 v8, 0
    v_mov_b32 v9, 1
    ds_write_b32 v8, v9 offset:10496
    s_lshl_b32 s55, s4, 14
    s_add_u32 s55, s55, 131072
    s_add_u32 s52, s30, s55
    s_addc_u32 s53, s31, 0
    s_mov_b32 s62, 20000
L_pq0s0:
    s_load_dword s72, s[52:53], 0x4 glc
    s_load_dword s73, s[52:53], 0x204 glc
    s_load_dword s74, s[52:53], 0x1004 glc
    s_load_dword s75, s[52:53], 0x1204 glc
    s_load_dword s76, s[52:53], 0x2004 glc
    s_load_dword s77, s[52:53], 0x2204 glc
    s_load_dword s78, s[52:53], 0x3004 glc
    s_load_dword s79, s[52:53], 0x3204 glc
    s_waitcnt lgkmcnt(0)
    s_cmp_lg_u32 s72, s6
    s_cbranch_scc1 L_pq0s0_r
    s_cmp_lg_u32 s73, s6
    s_cbranch_scc1 L_pq0s0_r
    s_cmp_lg_u32 s74, s6
    s_cbranch_scc1 L_pq0s0_r
    s_cmp_lg_u32 s75, s6
    s_cbranch_scc1 L_pq0s0_r
    s_cmp_lg_u32 s76, s6
    s_cbranch_scc1 L_pq0s0_r
    s_cmp_lg_u32 s77, s6
    s_cbranch_scc1 L_pq0s0_r
    s_cmp_lg_u32 s78, s6
    s_cbranch_scc1 L_pq0s0_r
    s_cmp_lg_u32 s79, s6
    s_cbranch_scc1 L_pq0s0_r
    s_branch L_pq0s0_ok
L_pq0s0_r:
    s_sleep 2
    s_sub_u32 s62, s62, 1
    s_cmp_lg_u32 s62, 0
    s_cbranch_scc1 L_pq0s0
L_pq0s0_ok:
    v_lshlrev_b32 v8, 4, v1
    v_add_u32 v8, s55, v8
    v_add_u32 v7, 8192, v8
    s_mov_b32 s58, 4096
    s_mov_b32 s62, 200000
L_pq0:
    buffer_load_dwordx4 v[64:67], v8, s[40:43], 0 offen offset:0 sc1
    buffer_load_dwordx4 v[68:71], v8, s[40:43], s58 offen offset:0 sc1
    buffer_load_dwordx4 v[72:75], v7, s[40:43], 0 offen offset:0 sc1
    buffer_load_dwordx4 v[76:79], v7, s[40:43], s58 offen offset:0 sc1
    s_mov_b64 exec, -1
    s_waitcnt vmcnt(0)
    v_xor_b32 v9, s6, v65
    v_bitop3_b32 v9, v67, s6, v9 bitop3:0xbe
    v_bitop3_b32 v9, v69, s6, v9 bitop3:0xbe
    v_bitop3_b32 v9, v71, s6, v9 bitop3:0xbe
    v_bitop3_b32 v9, v73, s6, v9 bitop3:0xbe
    v_bitop3_b32 v9, v75, s6, v9 bitop3:0xbe
    v_bitop3_b32 v9, v77, s6, v9 bitop3:0xbe
    v_bitop3_b32 v9, v79, s6, v9 bitop3:0xbe
    v_cmp_ne_u32 vcc, 0, v9
    s_cbranch_vccz L_pq0_ok
    s_sleep 2
    s_sub_u32 s62, s62, 1
    s_cmp_lg_u32 s62, 0
    s_cbranch_scc1 L_pq0
L_pq0_ok:
    v_lshlrev_b32 v9, 2, v1
    v_add_f32 v10, v64, v68
    v_add_f32 v11, v66, v70
    v_add_f32 v12, v72, v76
    v_add_f32 v13, v74, v78
    v_add_f32 v10, v10, v12
    v_add_f32 v11, v11, v13
    v_cvt_pk_bf16_f32 v14, v10, v11
    ds_write_b32 v9, v14 offset:0
    s_waitcnt lgkmcnt(0)
    v_mov_b32 v8, 0
    v_mov_b32 v9, 1
    ds_write_b32 v8, v9 offset:10512
    s_endpgm
L_h1:
    s_barrier
    s_mov_b32 s40, s30
    s_mov_b32 s41, s31
    s_mov_b32 s42, 4194304
    s_mov_b32 s43, 0x20000
    s_waitcnt lgkmcnt(0)
    s_mul_i32 s6, s6, 0x9E3779B1
    s_add_u32 s6, s6, 0x7F4A7C15
    s_mov_b32 s61, s2
    s_lshr_b32 s54, s2, 3
    s_and_b32 s55, s2, 7
    s_and_b32 s56, s54, 7
    s_cmp_eq_u32 s55, s56
    s_cbranch_scc1 L_end
    s_cmp_gt_u32 s55, s56
    s_cselect_b32 s56, 1, 0
    s_sub_u32 s55, s55, s56
    s_mul_i32 s54, s54, 7
    s_add_u32 s2, s54, s55
    s_mov_b32 s62, 200000
    v_mov_b32 v8, 0
    s_nop 1
L_xg:
    ds_read_b32 v9, v8 offset:10500
    s_waitcnt lgkmcnt(0)
    v_cmp_eq_u32 vcc, 0, v9
    s_cbranch_vccz L_xg_ok
    s_sleep 4
    s_sub_u32 s62, s62, 1
    s_cmp_lg_u32 s62, 0
    s_cbranch_scc1 L_xg
L_xg_ok:
    s_mov_b32 s36, s20
    s_mov_b32 s37, s21
    s_mov_b32 s38, 1605632
    s_mov_b32 s39, 0x20000
    s_mov_b32 s44, s22
    s_mov_b32 s45, s23
    s_mov_b32 s46, 1605632
    s_mov_b32 s47, 0x20000
    s_mov_b32 s48, s24
    s_mov_b32 s49, s25
    s_mov_b32 s50, 1605632
    s_mov_b32 s51, 0x20000
    s_lshr_b32 s54, s2, 3
    s_and_b32 s59, s2, 7
    s_lshl_b32 s55, s54, 7
    s_mul_i32 s56, s59, 200704
    s_add_u32 s55, s55, s56
    v_lshrrev_b32 v3, 3, v1
    v_mul_u32_u24 v3, 3584, v3
    v_and_b32 v8, 7, v1
    v_lshlrev_b32 v8, 4, v8
    v_add3_u32 v3, v3, v8, s55
    s_mov_b32 s57, 0
    buffer_load_dwordx4 v[64:67], v3, s[36:39], s57 offen nt
    buffer_load_dwordx4 v[92:95], v3, s[44:47], s57 offen nt
    s_mov_b32 s57, 28672
    s_waitcnt vmcnt(1)
    buffer_load_dwordx4 v[68:71], v3, s[36:39], s57 offen nt
    s_waitcnt vmcnt(1)
    buffer_load_dwordx4 v[96:99], v3, s[44:47], s57 offen nt
    s_mov_b32 s57, 57344
    s_waitcnt vmcnt(1)
    buffer_load_dwordx4 v[72:75], v3, s[36:39], s57 offen nt
    s_waitcnt vmcnt(1)
    buffer_load_dwordx4 v[100:103], v3, s[44:47], s57 offen nt
    s_mov_b32 s57, 86016
    s_waitcnt vmcnt(1)
    buffer_load_dwordx4 v[76:79], v3, s[36:39], s57 offen nt
    s_waitcnt vmcnt(1)
    buffer_load_dwordx4 v[104:107], v3, s[44:47], s57 offen nt
    s_mov_b32 s57, 114688
    s_waitcnt vmcnt(1)
    buffer_load_dwordx4 v[80:83], v3, s[36:39], s57 offen nt
    s_waitcnt vmcnt(1)
    buffer_load_dwordx4 v[108:111], v3, s[44:47], s57 offen nt
    s_mov_b32 s57, 143360
    s_waitcnt vmcnt(1)
    buffer_load_dwordx4 v[84:87], v3, s[36:39], s57 offen nt
    s_waitcnt vmcnt(1)
    buffer_load_dwordx4 v[112:115], v3, s[44:47], s57 offen nt
    s_mov_b32 s57, 172032
    s_waitcnt vmcnt(1)
    buffer_load_dwordx4 v[88:91], v3, s[36:39], s57 offen nt
    s_waitcnt vmcnt(1)
    buffer_load_dwordx4 v[116:119], v3, s[44:47], s57 offen nt
    v_lshrrev_b32 v60, 4, v1
    v_lshlrev_b32 v60, 1, v60
    s_lshl_b32 s55, s2, 3
    v_add_u32 v60, s55, v60
    v_mul_u32_u24 v60, 896, v60
    v_and_b32 v9, 15, v1
    v_lshlrev_b32 v9, 4, v9
    v_add_u32 v60, v60, v9
    s_mul_i32 s56, s59, 224
    v_lshrrev_b32 v9, 3, v1
    v_lshlrev_b32 v9, 2, v9
    v_add_u32 v9, s56, v9
    ds_read_b32 v32, v9 offset:12288
    ds_read_b32 v33, v9 offset:12320
    ds_read_b32 v34, v9 offset:12352
    ds_read_b32 v35, v9 offset:12384
    ds_read_b32 v36, v9 offset:12416
    ds_read_b32 v37, v9 offset:12448
    ds_read_b32 v38, v9 offset:12480
    v_mov_b32 v10, 0
    v_mov_b32 v11, 0
    v_mov_b32 v12, 0
    v_mov_b32 v13, 0
    v_mov_b32 v14, 0
    v_mov_b32 v15, 0
    v_mov_b32 v16, 0
    v_mov_b32 v17, 0
    v_mov_b32 v18, 0
    v_mov_b32 v19, 0
    v_mov_b32 v20, 0
    v_mov_b32 v21, 0
    v_mov_b32 v22, 0
    v_mov_b32 v23, 0
    v_mov_b32 v24, 0
    v_mov_b32 v25, 0
    s_mul_i32 s55, s59, 14336
    s_lshl_b32 s56, s54, 9
    s_add_u32 s55, s55, s56
    s_add_u32 s55, s55, 262144
    v_and_b32 v2, 7, v1
    v_lshlrev_b32 v2, 6, v2
    v_lshrrev_b32 v8, 4, v1
    v_lshlrev_b32 v8, 4, v8
    v_add3_u32 v2, v2, v8, s55
    v_add_u32 v3, 114688, v2
    s_waitcnt lgkmcnt(0)
    v_lshlrev_b32 v46, 16, v32
    v_lshlrev_b32 v47, 16, v33
    v_lshlrev_b32 v48, 16, v34
    v_lshlrev_b32 v49, 16, v35
    v_lshlrev_b32 v50, 16, v36
    v_lshlrev_b32 v51, 16, v37
    v_lshlrev_b32 v52, 16, v38
    s_waitcnt vmcnt(0)
    v_dot2c_f32_bf16 v10, v64, v32
    v_dot2c_f32_bf16 v11, v64, v46
    v_dot2c_f32_bf16 v18, v92, v32
    v_dot2c_f32_bf16 v19, v92, v46
    v_dot2c_f32_bf16 v12, v65, v32
    v_dot2c_f32_bf16 v13, v65, v46
    v_dot2c_f32_bf16 v20, v93, v32
    v_dot2c_f32_bf16 v21, v93, v46
    v_dot2c_f32_bf16 v14, v66, v32
    v_dot2c_f32_bf16 v15, v66, v46
    v_dot2c_f32_bf16 v22, v94, v32
    v_dot2c_f32_bf16 v23, v94, v46
    v_dot2c_f32_bf16 v16, v67, v32
    v_dot2c_f32_bf16 v17, v67, v46
    v_dot2c_f32_bf16 v24, v95, v32
    v_dot2c_f32_bf16 v25, v95, v46
    v_dot2c_f32_bf16 v10, v68, v33
    v_dot2c_f32_bf16 v11, v68, v47
    v_dot2c_f32_bf16 v18, v96, v33
    v_dot2c_f32_bf16 v19, v96, v47
    v_dot2c_f32_bf16 v12, v69, v33
    v_dot2c_f32_bf16 v13, v69, v47
    v_dot2c_f32_bf16 v20, v97, v33
    v_dot2c_f32_bf16 v21, v97, v47
    v_dot2c_f32_bf16 v14, v70, v33
    v_dot2c_f32_bf16 v15, v70, v47
    v_dot2c_f32_bf16 v22, v98, v33
    v_dot2c_f32_bf16 v23, v98, v47
    v_dot2c_f32_bf16 v16, v71, v33
    v_dot2c_f32_bf16 v17, v71, v47
    v_dot2c_f32_bf16 v24, v99, v33
    v_dot2c_f32_bf16 v25, v99, v47
    v_dot2c_f32_bf16 v10, v72, v34
    v_dot2c_f32_bf16 v11, v72, v48
    v_dot2c_f32_bf16 v18, v100, v34
    v_dot2c_f32_bf16 v19, v100, v48
    v_dot2c_f32_bf16 v12, v73, v34
    v_dot2c_f32_bf16 v13, v73, v48
    v_dot2c_f32_bf16 v20, v101, v34
    v_dot2c_f32_bf16 v21, v101, v48
    v_dot2c_f32_bf16 v14, v74, v34
    v_dot2c_f32_bf16 v15, v74, v48
    v_dot2c_f32_bf16 v22, v102, v34
    v_dot2c_f32_bf16 v23, v102, v48
    v_dot2c_f32_bf16 v16, v75, v34
    v_dot2c_f32_bf16 v17, v75, v48
    v_dot2c_f32_bf16 v24, v103, v34
    v_dot2c_f32_bf16 v25, v103, v48
    v_dot2c_f32_bf16 v10, v76, v35
    v_dot2c_f32_bf16 v11, v76, v49
    v_dot2c_f32_bf16 v18, v104, v35
    v_dot2c_f32_bf16 v19, v104, v49
    v_dot2c_f32_bf16 v12, v77, v35
    v_dot2c_f32_bf16 v13, v77, v49
    v_dot2c_f32_bf16 v20, v105, v35
    v_dot2c_f32_bf16 v21, v105, v49
    v_dot2c_f32_bf16 v14, v78, v35
    v_dot2c_f32_bf16 v15, v78, v49
    v_dot2c_f32_bf16 v22, v106, v35
    v_dot2c_f32_bf16 v23, v106, v49
    v_dot2c_f32_bf16 v16, v79, v35
    v_dot2c_f32_bf16 v17, v79, v49
    v_dot2c_f32_bf16 v24, v107, v35
    v_dot2c_f32_bf16 v25, v107, v49
    v_dot2c_f32_bf16 v10, v80, v36
    v_dot2c_f32_bf16 v11, v80, v50
    v_dot2c_f32_bf16 v18, v108, v36
    v_dot2c_f32_bf16 v19, v108, v50
    v_dot2c_f32_bf16 v12, v81, v36
    v_dot2c_f32_bf16 v13, v81, v50
    v_dot2c_f32_bf16 v20, v109, v36
    v_dot2c_f32_bf16 v21, v109, v50
    v_dot2c_f32_bf16 v14, v82, v36
    v_dot2c_f32_bf16 v15, v82, v50
    v_dot2c_f32_bf16 v22, v110, v36
    v_dot2c_f32_bf16 v23, v110, v50
    v_dot2c_f32_bf16 v16, v83, v36
    v_dot2c_f32_bf16 v17, v83, v50
    v_dot2c_f32_bf16 v24, v111, v36
    v_dot2c_f32_bf16 v25, v111, v50
    v_dot2c_f32_bf16 v10, v84, v37
    v_dot2c_f32_bf16 v11, v84, v51
    v_dot2c_f32_bf16 v18, v112, v37
    v_dot2c_f32_bf16 v19, v112, v51
    v_dot2c_f32_bf16 v12, v85, v37
    v_dot2c_f32_bf16 v13, v85, v51
    v_dot2c_f32_bf16 v20, v113, v37
    v_dot2c_f32_bf16 v21, v113, v51
    v_dot2c_f32_bf16 v14, v86, v37
    v_dot2c_f32_bf16 v15, v86, v51
    v_dot2c_f32_bf16 v22, v114, v37
    v_dot2c_f32_bf16 v23, v114, v51
    v_dot2c_f32_bf16 v16, v87, v37
    v_dot2c_f32_bf16 v17, v87, v51
    v_dot2c_f32_bf16 v24, v115, v37
    v_dot2c_f32_bf16 v25, v115, v51
    v_dot2c_f32_bf16 v10, v88, v38
    v_dot2c_f32_bf16 v11, v88, v52
    v_dot2c_f32_bf16 v18, v116, v38
    v_dot2c_f32_bf16 v19, v116, v52
    v_dot2c_f32_bf16 v12, v89, v38
    v_dot2c_f32_bf16 v13, v89, v52
    v_dot2c_f32_bf16 v20, v117, v38
    v_dot2c_f32_bf16 v21, v117, v52
    v_dot2c_f32_bf16 v14, v90, v38
    v_dot2c_f32_bf16 v15, v90, v52
    v_dot2c_f32_bf16 v22, v118, v38
    v_dot2c_f32_bf16 v23, v118, v52
    v_dot2c_f32_bf16 v16, v91, v38
    v_dot2c_f32_bf16 v17, v91, v52
    v_dot2c_f32_bf16 v24, v119, v38
    v_dot2c_f32_bf16 v25, v119, v52
    v_permlane32_swap_b32 v10, v14
    v_permlane32_swap_b32 v11, v15
    v_permlane32_swap_b32 v12, v16
    v_permlane32_swap_b32 v13, v17
    v_add_f32 v10, v10, v14
    v_add_f32 v11, v11, v15
    v_add_f32 v12, v12, v16
    v_add_f32 v13, v13, v17
    s_nop 0
    v_permlane16_swap_b32 v10, v12
    v_permlane16_swap_b32 v11, v13
    v_add_f32 v10, v10, v12
    v_add_f32 v11, v11, v13
    s_nop 0
    v_add_f32_dpp v10, v10, v10 row_ror:8 row_mask:0xf bank_mask:0xf
    v_add_f32_dpp v11, v11, v11 row_ror:8 row_mask:0xf bank_mask:0xf
    v_permlane32_swap_b32 v18, v22
    v_permlane32_swap_b32 v19, v23
    v_permlane32_swap_b32 v20, v24
    v_permlane32_swap_b32 v21, v25
    v_add_f32 v18, v18, v22
    v_add_f32 v19, v19, v23
    v_add_f32 v20, v20, v24
    v_add_f32 v21, v21, v25
    s_nop 0
    v_permlane16_swap_b32 v18, v20
    v_permlane16_swap_b32 v19, v21
    v_add_f32 v18, v18, v20
    v_add_f32 v19, v19, v21
    s_nop 0
    v_add_f32_dpp v18, v18, v18 row_ror:8 row_mask:0xf bank_mask:0xf
    v_add_f32_dpp v19, v19, v19 row_ror:8 row_mask:0xf bank_mask:0xf
    v_mov_b32 v12, v11
    v_mov_b32 v11, s6
    v_mov_b32 v13, s6
    s_mov_b32 exec_lo, 0x00ff00ff
    s_mov_b32 exec_hi, 0x00ff00ff
    buffer_store_dwordx4 v[10:13], v2, s[40:43], 0 offen sc1
    s_mov_b64 exec, -1
    v_mov_b32 v20, v19
    v_mov_b32 v19, s6
    v_mov_b32 v21, s6
    s_mov_b32 exec_lo, 0x00ff00ff
    s_mov_b32 exec_hi, 0x00ff00ff
    buffer_store_dwordx4 v[18:21], v3, s[40:43], 0 offen sc1
    s_mov_b64 exec, -1
    v_lshrrev_b32 v8, 3, v1
    v_bfe_u32 v9, v1, 2, 1
    v_lshlrev_b32 v9, 3, v9
    v_add_u32 v8, v8, v9
    v_mul_u32_u24 v8, 14336, v8
    s_lshl_b32 s55, s2, 6
    s_add_u32 s55, s55, 262144
    v_and_b32 v9, 3, v1
    v_lshlrev_b32 v9, 4, v9
    v_add3_u32 v8, v8, v9, s55
    v_and_b32 v4, 1, v1
    v_lshlrev_b32 v4, 4, v4
    v_mov_b32 v5, 0xffff
    v_lshlrev_b32 v4, v4, v5
    v_bfe_u32 v5, v1, 1, 2
    v_cmp_eq_u32 vcc, 0, v5
    s_nop 1
    v_cndmask_b32 v28, 0, v4, vcc
    v_cmp_eq_u32 vcc, 1, v5
    s_nop 1
    v_cndmask_b32 v29, 0, v4, vcc
    v_cmp_eq_u32 vcc, 2, v5
    s_nop 1
    v_cndmask_b32 v30, 0, v4, vcc
    v_cmp_eq_u32 vcc, 3, v5
    s_nop 1
    v_cndmask_b32 v31, 0, v4, vcc
    v_lshrrev_b32 v2, 3, v1
    v_lshlrev_b32 v2, 15, v2
    v_and_b32 v4, 7, v1
    v_lshlrev_b32 v4, 4, v4
    s_lshl_b32 s55, s2, 7
    s_add_u32 s55, s55, 524288
    v_add3_u32 v2, v2, v4, s55
    v_lshrrev_b32 v56, 2, v1
    v_bfe_u32 v57, v1, 1, 1
    v_lshlrev_b32 v57, 4, v57
    v_add_u32 v56, v56, v57
    v_and_b32 v57, 1, v1
    v_lshlrev_b32 v57, 5, v57
    v_add_u32 v56, v56, v57
    v_lshlrev_b32 v56, 2, v56
    v_mov_b32 v161, s6
    v_mov_b32 v163, s6
    v_mov_b32 v165, s6
    v_mov_b32 v167, s6
    v_mov_b32 v169, s6
    v_mov_b32 v171, s6
    v_mov_b32 v173, s6
    v_mov_b32 v175, s6
    s_mov_b32 s70, 0
    s_mov_b32 s71, -1
    s_mov_b32 s64, 0
    s_mov_b32 s65, 262144
    s_mov_b32 s66, 524288
    s_mov_b32 s67, 786432
    s_lshl_b32 s55, s2, 6
    s_add_u32 s55, s55, 376832
    s_add_u32 s52, s30, s55
    s_addc_u32 s53, s31, 0
    s_mov_b32 s62, 20000
L_sg:
    s_load_dword s72, s[52:53], 0x4 glc
    s_load_dword s73, s[52:53], 0x3804 glc
    s_load_dword s74, s[52:53], 0x7004 glc
    s_load_dword s75, s[52:53], 0xa804 glc
    s_load_dword s76, s[52:53], 0xe004 glc
    s_load_dword s77, s[52:53], 0x11804 glc
    s_load_dword s78, s[52:53], 0x15004 glc
    s_load_dword s79, s[52:53], 0x18804 glc
    s_waitcnt lgkmcnt(0)
    s_cmp_lg_u32 s72, s6
    s_cbranch_scc1 L_sg_r
    s_cmp_lg_u32 s73, s6
    s_cbranch_scc1 L_sg_r
    s_cmp_lg_u32 s74, s6
    s_cbranch_scc1 L_sg_r
    s_cmp_lg_u32 s75, s6
    s_cbranch_scc1 L_sg_r
    s_cmp_lg_u32 s76, s6
    s_cbranch_scc1 L_sg_r
    s_cmp_lg_u32 s77, s6
    s_cbranch_scc1 L_sg_r
    s_cmp_lg_u32 s78, s6
    s_cbranch_scc1 L_sg_r
    s_cmp_lg_u32 s79, s6
    s_cbranch_scc1 L_sg_r
    s_branch L_sg_ok
L_sg_r:
    s_sleep 16
    s_sub_u32 s62, s62, 1
    s_cmp_lg_u32 s62, 0
    s_cbranch_scc1 L_sg
L_sg_ok:
    s_mov_b32 s62, 200000
L_pg:
    buffer_load_dwordx4 v[64:67], v8, s[40:43], 0 offen sc1
    s_mov_b64 exec, -1
    s_waitcnt vmcnt(0)
    v_xor_b32 v9, s6, v65
    v_bitop3_b32 v9, v67, s6, v9 bitop3:0xbe
    v_cmp_ne_u32 vcc, 0, v9
    s_cbranch_vccz L_pg_ok
    s_sleep 16
    s_sub_u32 s62, s62, 1
    s_cmp_lg_u32 s62, 0
    s_cbranch_scc1 L_pg
L_pg_ok:
    v_mov_b32 v10, v64
    v_mov_b32 v11, v66
    s_nop 0
    v_add_f32_dpp v10, v10, v10 row_ror:8 row_mask:0xf bank_mask:0xf
    v_add_f32_dpp v11, v11, v11 row_ror:8 row_mask:0xf bank_mask:0xf
    v_mov_b32 v12, v10
    v_mov_b32 v13, v11
    s_nop 0
    v_permlane16_swap_b32 v10, v12
    v_permlane16_swap_b32 v11, v13
    v_add_f32 v10, v10, v12
    v_add_f32 v11, v11, v13
    v_mov_b32 v12, v10
    v_mov_b32 v13, v11
    s_nop 0
    v_permlane32_swap_b32 v10, v12
    v_permlane32_swap_b32 v11, v13
    v_add_f32 v10, v10, v12
    v_add_f32 v11, v11, v13
    v_cvt_pk_bf16_f32 v10, v10, 0
    v_lshlrev_b32 v10, 16, v10
    v_cvt_pk_bf16_f32 v11, v11, 0
    v_lshlrev_b32 v11, 16, v11
    v_mov_b32_dpp v14, v10 row_ror:4 row_mask:0xf bank_mask:0xf
    s_nop 0
    v_mov_b32_dpp v15, v11 row_ror:4 row_mask:0xf bank_mask:0xf
    v_mov_b32 v26, 0x3d372713
    v_mov_b32 v27, 0xc0135761
    v_mul_f32 v18, v10, v10
    v_mul_f32 v19, v11, v11
    v_fma_f32 v18, v18, v26, 1.0
    v_fma_f32 v19, v19, v26, 1.0
    v_mul_f32 v18, v18, v10
    v_mul_f32 v19, v19, v11
    v_mul_f32 v18, v27, v18
    v_mul_f32 v19, v27, v19
    v_exp_f32 v18, v18
    v_exp_f32 v19, v19
    v_add_f32 v18, 1.0, v18
    v_add_f32 v19, 1.0, v19
    v_rcp_f32 v18, v18
    v_rcp_f32 v19, v19
    v_mul_f32 v18, v18, v10
    v_mul_f32 v19, v19, v11
    v_cvt_pk_bf16_f32 v18, v18, 0
    v_lshlrev_b32 v18, 16, v18
    v_cvt_pk_bf16_f32 v19, v19, 0
    v_lshlrev_b32 v19, 16, v19
    v_mul_f32 v18, v18, v14
    v_mul_f32 v19, v19, v15
    v_cvt_pk_bf16_f32 v18, v18, v18
    v_cvt_pk_bf16_f32 v19, v19, v19
    s_nop 0
    v_mov_b32_dpp v22, v18 row_newbcast:0 row_mask:0x1 bank_mask:0xf
    s_nop 1
    v_mov_b32_dpp v22, v18 row_newbcast:1 row_mask:0x2 bank_mask:0xf
    s_nop 1
    v_mov_b32_dpp v22, v18 row_newbcast:2 row_mask:0x4 bank_mask:0xf
    s_nop 1
    v_mov_b32_dpp v22, v18 row_newbcast:3 row_mask:0x8 bank_mask:0xf
    v_mov_b32_dpp v23, v19 row_newbcast:0 row_mask:0x1 bank_mask:0xf
    s_nop 1
    v_mov_b32_dpp v23, v19 row_newbcast:1 row_mask:0x2 bank_mask:0xf
    s_nop 1
    v_mov_b32_dpp v23, v19 row_newbcast:2 row_mask:0x4 bank_mask:0xf
    s_nop 1
    v_mov_b32_dpp v23, v19 row_newbcast:3 row_mask:0x8 bank_mask:0xf
    s_mov_b32 s62, 200000
    v_mov_b32 v8, 0
    s_nop 1
L_ydr:
    ds_read_b32 v9, v8 offset:10508
    s_waitcnt lgkmcnt(0)
    v_cmp_eq_u32 vcc, 0, v9
    s_cbranch_vccz L_ydr_ok
    s_sleep 3
    s_sub_u32 s62, s62, 1
    s_cmp_lg_u32 s62, 0
    s_cbranch_scc1 L_ydr
L_ydr_ok:
    buffer_load_dwordx4 v[120:123], v60, s[48:51], 0 offen offset:0 nt
    buffer_load_dwordx4 v[124:127], v60, s[48:51], 0 offen offset:256 nt
    buffer_load_dwordx4 v[128:131], v60, s[48:51], 0 offen offset:512 nt
    s_mov_b32 exec_lo, 0x00ff00ff
    s_mov_b32 exec_hi, 0x00ff00ff
    buffer_load_dwordx4 v[132:135], v60, s[48:51], 0 offen offset:768 nt
    s_mov_b64 exec, -1
    buffer_load_dwordx4 v[136:139], v60, s[48:51], 0 offen offset:896 nt
    buffer_load_dwordx4 v[140:143], v60, s[48:51], 0 offen offset:1152 nt
    buffer_load_dwordx4 v[144:147], v60, s[48:51], 0 offen offset:1408 nt
    s_mov_b32 exec_lo, 0x00ff00ff
    s_mov_b32 exec_hi, 0x00ff00ff
    buffer_load_dwordx4 v[148:151], v60, s[48:51], 0 offen offset:1664 nt
    s_mov_b64 exec, -1
    s_waitcnt vmcnt(0)
    v_and_b32 v32, v22, v28
    v_and_b32 v33, v22, v29
    v_and_b32 v34, v22, v30
    v_and_b32 v35, v22, v31
    s_nop 1
    v_mfma_f32_16x16x32_bf16 v[40:43], v[32:35], v[120:123], 0
    v_mfma_f32_16x16x32_bf16 v[44:47], v[32:35], v[124:127], 0
    v_mfma_f32_16x16x32_bf16 v[48:51], v[32:35], v[128:131], 0
    v_mfma_f32_16x16x32_bf16 v[52:55], v[32:35], v[132:135], 0
    v_and_b32 v36, v23, v28
    v_and_b32 v37, v23, v29
    v_and_b32 v38, v23, v30
    v_and_b32 v39, v23, v31
    s_nop 1
    v_mfma_f32_16x16x32_bf16 v[40:43], v[36:39], v[136:139], v[40:43]
    v_mfma_f32_16x16x32_bf16 v[44:47], v[36:39], v[140:143], v[44:47]
    v_mfma_f32_16x16x32_bf16 v[48:51], v[36:39], v[144:147], v[48:51]
    v_mfma_f32_16x16x32_bf16 v[52:55], v[36:39], v[148:151], v[52:55]
    s_nop 4
    v_cndmask_b32 v40, v40, v42, s[70:71]
    v_cndmask_b32 v41, v41, v43, s[70:71]
    ds_bpermute_b32 v160, v56, v40
    ds_bpermute_b32 v162, v56, v41
    v_cndmask_b32 v44, v44, v46, s[70:71]
    v_cndmask_b32 v45, v45, v47, s[70:71]
    ds_bpermute_b32 v164, v56, v44
    ds_bpermute_b32 v166, v56, v45
    v_cndmask_b32 v48, v48, v50, s[70:71]
    v_cndmask_b32 v49, v49, v51, s[70:71]
    ds_bpermute_b32 v168, v56, v48
    ds_bpermute_b32 v170, v56, v49
    v_cndmask_b32 v52, v52, v54, s[70:71]
    v_cndmask_b32 v53, v53, v55, s[70:71]
    ds_bpermute_b32 v172, v56, v52
    ds_bpermute_b32 v174, v56, v53
    s_waitcnt lgkmcnt(6)
    buffer_store_dwordx4 v[160:163], v2, s[40:43], s64 offen sc1
    s_waitcnt lgkmcnt(4)
    buffer_store_dwordx4 v[164:167], v2, s[40:43], s65 offen sc1
    s_waitcnt lgkmcnt(2)
    buffer_store_dwordx4 v[168:171], v2, s[40:43], s66 offen sc1
    s_waitcnt lgkmcnt(0)
    s_mov_b32 exec_hi, 0
    buffer_store_dwordx4 v[172:175], v2, s[40:43], s67 offen sc1
    s_mov_b64 exec, -1
    s_mov_b32 s2, s61
    s_endpgm
L_h2:
    s_barrier
    s_mov_b32 s36, s16
    s_mov_b32 s37, s17
    s_mov_b32 s38, 3670016
    s_mov_b32 s39, 0x20000
    s_mov_b32 s40, s30
    s_mov_b32 s41, s31
    s_mov_b32 s42, 4194304
    s_mov_b32 s43, 0x20000
    s_waitcnt lgkmcnt(0)
    s_mul_i32 s6, s6, 0x9E3779B1
    s_add_u32 s6, s6, 0x7F4A7C15
    s_mov_b32 s62, 200000
    v_mov_b32 v8, 0
    s_nop 1
L_pq2_g:
    ds_read_b32 v9, v8 offset:10496
    s_waitcnt lgkmcnt(0)
    v_cmp_eq_u32 vcc, 0, v9
    s_cbranch_vccz L_pq2_g_ok
    s_sleep 2
    s_sub_u32 s62, s62, 1
    s_cmp_lg_u32 s62, 0
    s_cbranch_scc1 L_pq2_g
L_pq2_g_ok:
    s_lshl_b32 s55, s4, 14
    s_add_u32 s55, s55, 132096
    s_add_u32 s52, s30, s55
    s_addc_u32 s53, s31, 0
    s_mov_b32 s62, 20000
L_pq2s0:
    s_load_dword s72, s[52:53], 0x4 glc
    s_load_dword s73, s[52:53], 0x204 glc
    s_load_dword s74, s[52:53], 0x1004 glc
    s_load_dword s75, s[52:53], 0x1204 glc
    s_load_dword s76, s[52:53], 0x2004 glc
    s_load_dword s77, s[52:53], 0x2204 glc
    s_load_dword s78, s[52:53], 0x3004 glc
    s_load_dword s79, s[52:53], 0x3204 glc
    s_waitcnt lgkmcnt(0)
    s_cmp_lg_u32 s72, s6
    s_cbranch_scc1 L_pq2s0_r
    s_cmp_lg_u32 s73, s6
    s_cbranch_scc1 L_pq2s0_r
    s_cmp_lg_u32 s74, s6
    s_cbranch_scc1 L_pq2s0_r
    s_cmp_lg_u32 s75, s6
    s_cbranch_scc1 L_pq2s0_r
    s_cmp_lg_u32 s76, s6
    s_cbranch_scc1 L_pq2s0_r
    s_cmp_lg_u32 s77, s6
    s_cbranch_scc1 L_pq2s0_r
    s_cmp_lg_u32 s78, s6
    s_cbranch_scc1 L_pq2s0_r
    s_cmp_lg_u32 s79, s6
    s_cbranch_scc1 L_pq2s0_r
    s_branch L_pq2s0_ok
L_pq2s0_r:
    s_sleep 2
    s_sub_u32 s62, s62, 1
    s_cmp_lg_u32 s62, 0
    s_cbranch_scc1 L_pq2s0
L_pq2s0_ok:
    s_add_u32 s52, s30, s55
    s_addc_u32 s53, s31, 0
    s_mov_b32 s62, 20000
L_pq2s1:
    s_load_dword s72, s[52:53], 0x404 glc
    s_load_dword s73, s[52:53], 0x604 glc
    s_load_dword s74, s[52:53], 0x1404 glc
    s_load_dword s75, s[52:53], 0x1604 glc
    s_load_dword s76, s[52:53], 0x2404 glc
    s_load_dword s77, s[52:53], 0x2604 glc
    s_load_dword s78, s[52:53], 0x3404 glc
    s_load_dword s79, s[52:53], 0x3604 glc
    s_waitcnt lgkmcnt(0)
    s_cmp_lg_u32 s72, s6
    s_cbranch_scc1 L_pq2s1_r
    s_cmp_lg_u32 s73, s6
    s_cbranch_scc1 L_pq2s1_r
    s_cmp_lg_u32 s74, s6
    s_cbranch_scc1 L_pq2s1_r
    s_cmp_lg_u32 s75, s6
    s_cbranch_scc1 L_pq2s1_r
    s_cmp_lg_u32 s76, s6
    s_cbranch_scc1 L_pq2s1_r
    s_cmp_lg_u32 s77, s6
    s_cbranch_scc1 L_pq2s1_r
    s_cmp_lg_u32 s78, s6
    s_cbranch_scc1 L_pq2s1_r
    s_cmp_lg_u32 s79, s6
    s_cbranch_scc1 L_pq2s1_r
    s_branch L_pq2s1_ok
L_pq2s1_r:
    s_sleep 2
    s_sub_u32 s62, s62, 1
    s_cmp_lg_u32 s62, 0
    s_cbranch_scc1 L_pq2s1
L_pq2s1_ok:
    v_lshlrev_b32 v8, 4, v1
    v_add_u32 v8, s55, v8
    v_add_u32 v7, 8192, v8
    s_mov_b32 s58, 4096
    s_mov_b32 s62, 200000
L_pq2:
    buffer_load_dwordx4 v[64:67], v8, s[40:43], 0 offen offset:0 sc1
    buffer_load_dwordx4 v[68:71], v8, s[40:43], s58 offen offset:0 sc1
    buffer_load_dwordx4 v[72:75], v7, s[40:43], 0 offen offset:0 sc1
    buffer_load_dwordx4 v[76:79], v7, s[40:43], s58 offen offset:0 sc1
    buffer_load_dwordx4 v[80:83], v8, s[40:43], 0 offen offset:1024 sc1
    buffer_load_dwordx4 v[84:87], v8, s[40:43], s58 offen offset:1024 sc1
    buffer_load_dwordx4 v[88:91], v7, s[40:43], 0 offen offset:1024 sc1
    buffer_load_dwordx4 v[92:95], v7, s[40:43], s58 offen offset:1024 sc1
    s_mov_b64 exec, -1
    s_waitcnt vmcnt(0)
    v_xor_b32 v9, s6, v65
    v_bitop3_b32 v9, v67, s6, v9 bitop3:0xbe
    v_bitop3_b32 v9, v69, s6, v9 bitop3:0xbe
    v_bitop3_b32 v9, v71, s6, v9 bitop3:0xbe
    v_bitop3_b32 v9, v73, s6, v9 bitop3:0xbe
    v_bitop3_b32 v9, v75, s6, v9 bitop3:0xbe
    v_bitop3_b32 v9, v77, s6, v9 bitop3:0xbe
    v_bitop3_b32 v9, v79, s6, v9 bitop3:0xbe
    v_bitop3_b32 v9, v81, s6, v9 bitop3:0xbe
    v_bitop3_b32 v9, v83, s6, v9 bitop3:0xbe
    v_bitop3_b32 v9, v85, s6, v9 bitop3:0xbe
    v_bitop3_b32 v9, v87, s6, v9 bitop3:0xbe
    v_bitop3_b32 v9, v89, s6, v9 bitop3:0xbe
    v_bitop3_b32 v9, v91, s6, v9 bitop3:0xbe
    v_bitop3_b32 v9, v93, s6, v9 bitop3:0xbe
    v_bitop3_b32 v9, v95, s6, v9 bitop3:0xbe
    v_cmp_ne_u32 vcc, 0, v9
    s_cbranch_vccz L_pq2_ok
    s_sleep 2
    s_sub_u32 s62, s62, 1
    s_cmp_lg_u32 s62, 0
    s_cbranch_scc1 L_pq2
L_pq2_ok:
    v_lshlrev_b32 v9, 2, v1
    v_add_f32 v10, v64, v68
    v_add_f32 v11, v66, v70
    v_add_f32 v12, v72, v76
    v_add_f32 v13, v74, v78
    v_add_f32 v10, v10, v12
    v_add_f32 v11, v11, v13
    v_cvt_pk_bf16_f32 v14, v10, v11
    ds_write_b32 v9, v14 offset:256
    v_add_f32 v10, v80, v84
    v_add_f32 v11, v82, v86
    v_add_f32 v12, v88, v92
    v_add_f32 v13, v90, v94
    v_add_f32 v10, v10, v12
    v_add_f32 v11, v11, v13
    v_cvt_pk_bf16_f32 v15, v10, v11
    ds_write_b32 v9, v15 offset:512
    s_waitcnt lgkmcnt(0)
    v_mov_b32 v8, 0
    v_mov_b32 v9, 1
    ds_write_b32 v8, v9 offset:10516
    ds_write_b32 v8, v9 offset:10520
    s_lshl_b32 s54, s2, 4
    v_lshrrev_b32 v60, 4, v1
    v_lshlrev_b32 v60, 2, v60
    v_add_u32 v60, s54, v60
    v_mul_u32_u24 v60, 896, v60
    v_and_b32 v9, 15, v1
    v_lshlrev_b32 v9, 4, v9
    v_add_u32 v60, v60, v9
    v_and_b32 v8, 1, v1
    v_lshlrev_b32 v8, 4, v8
    v_mov_b32 v9, 0xffff
    v_lshlrev_b32 v8, v8, v9
    v_bfe_u32 v9, v1, 1, 2
    v_cmp_eq_u32 vcc, 0, v9
    s_nop 1
    v_cndmask_b32 v28, 0, v8, vcc
    v_cmp_eq_u32 vcc, 1, v9
    s_nop 1
    v_cndmask_b32 v29, 0, v8, vcc
    v_cmp_eq_u32 vcc, 2, v9
    s_nop 1
    v_cndmask_b32 v30, 0, v8, vcc
    v_cmp_eq_u32 vcc, 3, v9
    s_nop 1
    v_cndmask_b32 v31, 0, v8, vcc
    s_lshl_b32 s54, s2, 12
    s_add_u32 s54, s54, 1572864
    v_bfe_u32 v3, v1, 1, 3
    v_lshlrev_b32 v3, 7, v3
    v_lshrrev_b32 v8, 4, v1
    v_lshlrev_b32 v8, 5, v8
    v_add_u32 v3, v3, v8
    v_and_b32 v8, 1, v1
    v_lshlrev_b32 v8, 4, v8
    v_add3_u32 v3, v3, v8, s54
    v_lshrrev_b32 v2, 3, v1
    v_lshlrev_b32 v2, 15, v2
    v_and_b32 v8, 7, v1
    v_lshlrev_b32 v8, 4, v8
    s_lshl_b32 s55, s2, 7
    s_add_u32 s55, s55, 2621440
    v_add3_u32 v2, v2, v8, s55
    v_lshrrev_b32 v56, 2, v1
    v_bfe_u32 v57, v1, 1, 1
    v_lshlrev_b32 v57, 4, v57
    v_add_u32 v56, v56, v57
    v_and_b32 v57, 1, v1
    v_lshlrev_b32 v57, 5, v57
    v_add_u32 v56, v56, v57
    v_lshlrev_b32 v56, 2, v56
    v_mov_b32 v161, s6
    v_mov_b32 v163, s6
    v_mov_b32 v165, s6
    v_mov_b32 v167, s6
    v_mov_b32 v169, s6
    v_mov_b32 v171, s6
    v_mov_b32 v173, s6
    v_mov_b32 v175, s6
    s_mov_b32 s70, 0
    s_mov_b32 s71, -1
    s_mov_b32 s64, 0
    s_mov_b32 s65, 262144
    s_mov_b32 s66, 524288
    s_mov_b32 s67, 786432
    s_and_b32 s68, s6, 0xff
    s_mul_i32 s68, s68, 0x01010101
    s_mov_b32 s69, s68
    s_mov_b32 s62, 200000
    v_mov_b32 v8, 0
    s_nop 1
L_wop:
    ds_read_b32 v9, v8 offset:10508
    s_waitcnt lgkmcnt(0)
    v_cmp_eq_u32 vcc, 0, v9
    s_cbranch_vccz L_wop_ok
    s_sleep 8
    s_sub_u32 s62, s62, 1
    s_cmp_lg_u32 s62, 0
    s_cbranch_scc1 L_wop
L_wop_ok:
    s_mov_b32 s62, 200000
    v_mov_b32 v8, 0
    s_nop 1
L_woe:
    ds_read_b32 v9, v8 offset:11780
    s_waitcnt lgkmcnt(0)
    v_cmp_gt_u32 vcc, 1, v9
    s_cbranch_vccz L_woe_ok
    s_sleep 1
    s_sub_u32 s62, s62, 1
    s_cmp_lg_u32 s62, 0
    s_cbranch_scc1 L_woe
L_woe_ok:
    buffer_load_dwordx4 v[64:67], v60, s[36:39], 0 offen offset:0 nt
    buffer_load_dwordx4 v[68:71], v60, s[36:39], 0 offen offset:256 nt
    buffer_load_dwordx4 v[72:75], v60, s[36:39], 0 offen offset:512 nt
    s_mov_b32 exec_lo, 0x00ff00ff
    s_mov_b32 exec_hi, 0x00ff00ff
    buffer_load_dwordx4 v[76:79], v60, s[36:39], 0 offen offset:768 nt
    s_mov_b64 exec, -1
    buffer_load_dwordx4 v[80:83], v60, s[36:39], 0 offen offset:896 nt
    buffer_load_dwordx4 v[84:87], v60, s[36:39], 0 offen offset:1152 nt
    buffer_load_dwordx4 v[88:91], v60, s[36:39], 0 offen offset:1408 nt
    s_mov_b32 exec_lo, 0x00ff00ff
    s_mov_b32 exec_hi, 0x00ff00ff
    buffer_load_dwordx4 v[92:95], v60, s[36:39], 0 offen offset:1664 nt
    s_mov_b64 exec, -1
    buffer_load_dwordx4 v[96:99], v60, s[36:39], 0 offen offset:1792 nt
    buffer_load_dwordx4 v[100:103], v60, s[36:39], 0 offen offset:2048 nt
    buffer_load_dwordx4 v[104:107], v60, s[36:39], 0 offen offset:2304 nt
    s_mov_b32 exec_lo, 0x00ff00ff
    s_mov_b32 exec_hi, 0x00ff00ff
    buffer_load_dwordx4 v[108:111], v60, s[36:39], 0 offen offset:2560 nt
    s_mov_b64 exec, -1
    buffer_load_dwordx4 v[112:115], v60, s[36:39], 0 offen offset:2688 nt
    buffer_load_dwordx4 v[116:119], v60, s[36:39], 0 offen offset:2944 nt
    buffer_load_dwordx4 v[120:123], v60, s[36:39], 0 offen offset:3200 nt
    s_mov_b32 exec_lo, 0x00ff00ff
    s_mov_b32 exec_hi, 0x00ff00ff
    buffer_load_dwordx4 v[124:127], v60, s[36:39], 0 offen offset:3456 nt
    s_mov_b64 exec, -1
    s_mov_b32 s62, 200000
    v_mov_b32 v8, 0
    s_nop 1
L_h2w:
    ds_read_b32 v9, v8 offset:11780
    s_waitcnt lgkmcnt(0)
    v_cmp_gt_u32 vcc, 4, v9
    s_cbranch_vccz L_h2w_ok
    s_sleep 1
    s_sub_u32 s62, s62, 1
    s_cmp_lg_u32 s62, 0
    s_cbranch_scc1 L_h2w
L_h2w_ok:
    s_lshl_b32 s54, s2, 12
    s_add_u32 s54, s54, 1572864
    s_add_u32 s52, s30, s54
    s_addc_u32 s53, s31, 0
    s_mov_b32 s62, 20000
L_sh:
    s_load_dword s8, s[52:53], 0x28c glc
    s_load_dword s9, s[52:53], 0x78c glc
    s_load_dword s10, s[52:53], 0xd0c glc
    s_waitcnt lgkmcnt(0)
    s_cmp_lg_u32 s8, s6
    s_cbranch_scc1 L_sh_r
    s_cmp_lg_u32 s9, s6
    s_cbranch_scc1 L_sh_r
    s_cmp_lg_u32 s10, s6
    s_cbranch_scc1 L_sh_r
    s_branch L_sh_ok
L_sh_r:
    s_sub_u32 s62, s62, 1
    s_cmp_lg_u32 s62, 0
    s_cbranch_scc1 L_sh
L_sh_ok:
    s_mov_b32 s62, 200000
L_p1:
    buffer_load_dwordx4 v[128:131], v3, s[40:43], 0 offen offset:0 sc1
    buffer_load_dwordx4 v[132:135], v3, s[40:43], 0 offen offset:1024 sc1
    buffer_load_dwordx4 v[136:139], v3, s[40:43], 0 offen offset:2048 sc1
    buffer_load_dwordx4 v[140:143], v3, s[40:43], 0 offen offset:3072 sc1
    s_mov_b64 exec, -1
    s_waitcnt vmcnt(0)
    v_xor_b32 v9, s6, v131
    v_bitop3_b32 v9, v135, s6, v9 bitop3:0xbe
    v_bitop3_b32 v9, v139, s6, v9 bitop3:0xbe
    v_bitop3_b32 v9, v143, s6, v9 bitop3:0xbe
    v_cmp_ne_u32 vcc, 0, v9
    s_cbranch_vccz L_p1_ok
    s_sleep 1
    s_sub_u32 s62, s62, 1
    s_cmp_lg_u32 s62, 0
    s_cbranch_scc1 L_p1
L_p1_ok:
    v_mov_b32_dpp v144, v130 quad_perm:[0,0,2,2] row_mask:0xf bank_mask:0xf
    v_mov_b32_dpp v145, v134 quad_perm:[0,0,2,2] row_mask:0xf bank_mask:0xf
    v_mov_b32_dpp v146, v138 quad_perm:[0,0,2,2] row_mask:0xf bank_mask:0xf
    v_mov_b32_dpp v147, v142 quad_perm:[0,0,2,2] row_mask:0xf bank_mask:0xf
    v_max3_f32 v10, v144, v145, v146
    v_max_f32 v10, v10, v147
    v_mov_b32_dpp v148, v130 quad_perm:[1,1,3,3] row_mask:0xf bank_mask:0xf
    v_mov_b32_dpp v151, v142 quad_perm:[1,1,3,3] row_mask:0xf bank_mask:0xf
    v_max_f32_dpp v10, v10, v10 row_ror:2 row_mask:0xf bank_mask:0xf
    v_mov_b32_dpp v149, v134 quad_perm:[1,1,3,3] row_mask:0xf bank_mask:0xf
    s_nop 0
    v_max_f32_dpp v10, v10, v10 row_ror:4 row_mask:0xf bank_mask:0xf
    v_mov_b32_dpp v150, v138 quad_perm:[1,1,3,3] row_mask:0xf bank_mask:0xf
    s_nop 0
    v_max_f32_dpp v10, v10, v10 row_ror:8 row_mask:0xf bank_mask:0xf
    v_sub_f32 v12, v144, v10
    v_sub_f32 v13, v145, v10
    v_sub_f32 v14, v146, v10
    v_sub_f32 v15, v147, v10
    v_exp_f32 v12, v12
    v_exp_f32 v13, v13
    v_exp_f32 v14, v14
    v_exp_f32 v15, v15
    v_mul_f32 v16, v12, v148
    v_mul_f32 v17, v12, v128
    v_mul_f32 v18, v12, v129
    v_fmac_f32 v16, v13, v149
    v_fmac_f32 v17, v13, v132
    v_fmac_f32 v18, v13, v133
    v_fmac_f32 v16, v14, v150
    v_fmac_f32 v17, v14, v136
    v_fmac_f32 v18, v14, v137
    v_fmac_f32 v16, v15, v151
    v_fmac_f32 v17, v15, v140
    v_fmac_f32 v18, v15, v141
    v_add_f32_dpp v16, v16, v16 row_ror:2 row_mask:0xf bank_mask:0xf
    v_add_f32_dpp v17, v17, v17 row_ror:2 row_mask:0xf bank_mask:0xf
    v_add_f32_dpp v18, v18, v18 row_ror:2 row_mask:0xf bank_mask:0xf
    v_add_f32_dpp v16, v16, v16 row_ror:4 row_mask:0xf bank_mask:0xf
    v_add_f32_dpp v17, v17, v17 row_ror:4 row_mask:0xf bank_mask:0xf
    v_add_f32_dpp v18, v18, v18 row_ror:4 row_mask:0xf bank_mask:0xf
    v_add_f32_dpp v16, v16, v16 row_ror:8 row_mask:0xf bank_mask:0xf
    v_add_f32_dpp v17, v17, v17 row_ror:8 row_mask:0xf bank_mask:0xf
    v_add_f32_dpp v18, v18, v18 row_ror:8 row_mask:0xf bank_mask:0xf
    v_rcp_f32 v16, v16
    s_nop 0
    v_mul_f32 v17, v17, v16
    v_mul_f32 v18, v18, v16
    v_cvt_pk_bf16_f32 v17, v17, v17
    v_cvt_pk_bf16_f32 v18, v18, v18
    s_nop 0
    v_mov_b32_dpp v22, v17 quad_perm:[0,0,2,2] row_mask:0xf bank_mask:0xf
    v_mov_b32_dpp v23, v18 quad_perm:[0,0,2,2] row_mask:0xf bank_mask:0xf
    v_mov_b32_dpp v24, v17 quad_perm:[1,1,3,3] row_mask:0xf bank_mask:0xf
    v_mov_b32_dpp v25, v18 quad_perm:[1,1,3,3] row_mask:0xf bank_mask:0xf
    v_and_b32 v32, v22, v28
    v_and_b32 v33, v22, v29
    v_and_b32 v34, v22, v30
    v_and_b32 v35, v22, v31
    s_nop 1
    v_mfma_f32_16x16x32_bf16 v[40:43], v[32:35], v[64:67], 0
    v_mfma_f32_16x16x32_bf16 v[44:47], v[32:35], v[68:71], 0
    v_mfma_f32_16x16x32_bf16 v[48:51], v[32:35], v[72:75], 0
    v_mfma_f32_16x16x32_bf16 v[52:55], v[32:35], v[76:79], 0
    v_and_b32 v36, v23, v28
    v_and_b32 v37, v23, v29
    v_and_b32 v38, v23, v30
    v_and_b32 v39, v23, v31
    s_nop 1
    v_mfma_f32_16x16x32_bf16 v[40:43], v[36:39], v[80:83], v[40:43]
    v_mfma_f32_16x16x32_bf16 v[44:47], v[36:39], v[84:87], v[44:47]
    v_mfma_f32_16x16x32_bf16 v[48:51], v[36:39], v[88:91], v[48:51]
    v_mfma_f32_16x16x32_bf16 v[52:55], v[36:39], v[92:95], v[52:55]
    v_and_b32 v32, v24, v28
    v_and_b32 v33, v24, v29
    v_and_b32 v34, v24, v30
    v_and_b32 v35, v24, v31
    s_nop 1
    v_mfma_f32_16x16x32_bf16 v[40:43], v[32:35], v[96:99], v[40:43]
    v_mfma_f32_16x16x32_bf16 v[44:47], v[32:35], v[100:103], v[44:47]
    v_mfma_f32_16x16x32_bf16 v[48:51], v[32:35], v[104:107], v[48:51]
    v_mfma_f32_16x16x32_bf16 v[52:55], v[32:35], v[108:111], v[52:55]
    v_and_b32 v36, v25, v28
    v_and_b32 v37, v25, v29
    v_and_b32 v38, v25, v30
    v_and_b32 v39, v25, v31
    s_nop 1
    v_mfma_f32_16x16x32_bf16 v[40:43], v[36:39], v[112:115], v[40:43]
    v_mfma_f32_16x16x32_bf16 v[44:47], v[36:39], v[116:119], v[44:47]
    v_mfma_f32_16x16x32_bf16 v[48:51], v[36:39], v[120:123], v[48:51]
    v_mfma_f32_16x16x32_bf16 v[52:55], v[36:39], v[124:127], v[52:55]
    s_nop 4
    v_cndmask_b32 v40, v40, v42, s[70:71]
    v_cndmask_b32 v41, v41, v43, s[70:71]
    ds_bpermute_b32 v160, v56, v40
    ds_bpermute_b32 v162, v56, v41
    v_cndmask_b32 v44, v44, v46, s[70:71]
    v_cndmask_b32 v45, v45, v47, s[70:71]
    ds_bpermute_b32 v164, v56, v44
    ds_bpermute_b32 v166, v56, v45
    v_cndmask_b32 v48, v48, v50, s[70:71]
    v_cndmask_b32 v49, v49, v51, s[70:71]
    ds_bpermute_b32 v168, v56, v48
    ds_bpermute_b32 v170, v56, v49
    v_cndmask_b32 v52, v52, v54, s[70:71]
    v_cndmask_b32 v53, v53, v55, s[70:71]
    ds_bpermute_b32 v172, v56, v52
    ds_bpermute_b32 v174, v56, v53
    s_waitcnt lgkmcnt(6)
    buffer_store_dwordx4 v[160:163], v2, s[40:43], s64 offen sc1
    s_waitcnt lgkmcnt(4)
    buffer_store_dwordx4 v[164:167], v2, s[40:43], s65 offen sc1
    s_waitcnt lgkmcnt(2)
    buffer_store_dwordx4 v[168:171], v2, s[40:43], s66 offen sc1
    s_waitcnt lgkmcnt(0)
    s_mov_b32 exec_hi, 0
    buffer_store_dwordx4 v[172:175], v2, s[40:43], s67 offen sc1
    s_mov_b64 exec, -1
    s_barrier
    s_endpgm
L_h3:
    s_mov_b32 s40, s30
    s_mov_b32 s41, s31
    s_mov_b32 s42, 4194304
    s_mov_b32 s43, 0x20000
    s_waitcnt lgkmcnt(0)
    s_mul_i32 s6, s6, 0x9E3779B1
    s_add_u32 s6, s6, 0x7F4A7C15
    s_mov_b32 s62, 200000
    v_mov_b32 v8, 0
    s_nop 1
L_pq3_g:
    ds_read_b32 v9, v8 offset:10496
    s_waitcnt lgkmcnt(0)
    v_cmp_eq_u32 vcc, 0, v9
    s_cbranch_vccz L_pq3_g_ok
    s_sleep 2
    s_sub_u32 s62, s62, 1
    s_cmp_lg_u32 s62, 0
    s_cbranch_scc1 L_pq3_g
L_pq3_g_ok:
    s_lshl_b32 s55, s4, 14
    s_add_u32 s55, s55, 134144
    s_add_u32 s52, s30, s55
    s_addc_u32 s53, s31, 0
    s_mov_b32 s62, 20000
L_pq3s0:
    s_load_dword s72, s[52:53], 0x4 glc
    s_load_dword s73, s[52:53], 0x204 glc
    s_load_dword s74, s[52:53], 0x1004 glc
    s_load_dword s75, s[52:53], 0x1204 glc
    s_load_dword s76, s[52:53], 0x2004 glc
    s_load_dword s77, s[52:53], 0x2204 glc
    s_load_dword s78, s[52:53], 0x3004 glc
    s_load_dword s79, s[52:53], 0x3204 glc
    s_waitcnt lgkmcnt(0)
    s_cmp_lg_u32 s72, s6
    s_cbranch_scc1 L_pq3s0_r
    s_cmp_lg_u32 s73, s6
    s_cbranch_scc1 L_pq3s0_r
    s_cmp_lg_u32 s74, s6
    s_cbranch_scc1 L_pq3s0_r
    s_cmp_lg_u32 s75, s6
    s_cbranch_scc1 L_pq3s0_r
    s_cmp_lg_u32 s76, s6
    s_cbranch_scc1 L_pq3s0_r
    s_cmp_lg_u32 s77, s6
    s_cbranch_scc1 L_pq3s0_r
    s_cmp_lg_u32 s78, s6
    s_cbranch_scc1 L_pq3s0_r
    s_cmp_lg_u32 s79, s6
    s_cbranch_scc1 L_pq3s0_r
    s_branch L_pq3s0_ok
L_pq3s0_r:
    s_sleep 2
    s_sub_u32 s62, s62, 1
    s_cmp_lg_u32 s62, 0
    s_cbranch_scc1 L_pq3s0
L_pq3s0_ok:
    v_lshlrev_b32 v8, 4, v1
    v_add_u32 v8, s55, v8
    v_add_u32 v7, 8192, v8
    s_mov_b32 s58, 4096
    s_mov_b32 s62, 200000
L_pq3:
    buffer_load_dwordx4 v[64:67], v8, s[40:43], 0 offen offset:0 sc1
    buffer_load_dwordx4 v[68:71], v8, s[40:43], s58 offen offset:0 sc1
    buffer_load_dwordx4 v[72:75], v7, s[40:43], 0 offen offset:0 sc1
    buffer_load_dwordx4 v[76:79], v7, s[40:43], s58 offen offset:0 sc1
    s_mov_b64 exec, -1
    s_waitcnt vmcnt(0)
    v_xor_b32 v9, s6, v65
    v_bitop3_b32 v9, v67, s6, v9 bitop3:0xbe
    v_bitop3_b32 v9, v69, s6, v9 bitop3:0xbe
    v_bitop3_b32 v9, v71, s6, v9 bitop3:0xbe
    v_bitop3_b32 v9, v73, s6, v9 bitop3:0xbe
    v_bitop3_b32 v9, v75, s6, v9 bitop3:0xbe
    v_bitop3_b32 v9, v77, s6, v9 bitop3:0xbe
    v_bitop3_b32 v9, v79, s6, v9 bitop3:0xbe
    v_cmp_ne_u32 vcc, 0, v9
    s_cbranch_vccz L_pq3_ok
    s_sleep 2
    s_sub_u32 s62, s62, 1
    s_cmp_lg_u32 s62, 0
    s_cbranch_scc1 L_pq3
L_pq3_ok:
    v_lshlrev_b32 v9, 2, v1
    v_add_f32 v10, v64, v68
    v_add_f32 v11, v66, v70
    v_add_f32 v12, v72, v76
    v_add_f32 v13, v74, v78
    v_add_f32 v10, v10, v12
    v_add_f32 v11, v11, v13
    v_cvt_pk_bf16_f32 v14, v10, v11
    ds_write_b32 v9, v14 offset:768
    s_waitcnt lgkmcnt(0)
    v_mov_b32 v8, 0
    v_mov_b32 v9, 1
    ds_write_b32 v8, v9 offset:10524
    s_mov_b64 exec, 1
    s_andn2_b32 s54, s2, 31
    s_lshl_b32 s54, s54, 5
    s_add_u32 s54, s54, 65536
    v_mov_b32 v8, s54
    v_mov_b32 v0, 0
    s_andn2_b32 s48, s5, 31
    s_mov_b32 s46, 0
    s_mov_b32 s47, 22
    s_mov_b32 s49, 0
    s_andn2_b32 s54, s2, 31
    s_lshl_b32 s54, s54, 5
    s_add_u32 s54, s54, 65536
    s_add_u32 s52, s30, s54
    s_addc_u32 s53, s31, 0
    s_mov_b32 s63, 0
    s_mov_b32 s64, 32
    s_mov_b32 s65, 0
L_dsp:
    s_mov_b32 s62, 200000
    s_mov_b32 s67, s47
L_wp:
    ds_read_b32 v9, v0 offset:11776
    s_waitcnt lgkmcnt(0)
    v_readfirstlane_b32 s54, v9
    s_nop 0
    s_cmp_ge_u32 s54, s67
    s_cbranch_scc1 L_wp_ok
    s_sub_u32 s62, s62, 1
    s_cmp_eq_u32 s62, 0
    s_cbranch_scc1 L_dsp_end
    s_sleep 2
    s_branch L_wp
L_wp_ok:
    s_mov_b32 s54, 1
    s_atomic_add s54, s[52:53], 0x0 glc
    s_waitcnt lgkmcnt(0)
    s_cmp_ge_u32 s54, 256
    s_cbranch_scc1 L_dsp_end
    s_and_b32 s55, s54, 31
    s_add_u32 s55, s55, s48
    s_lshl_b32 s55, s55, 18
    s_lshr_b32 s54, s54, 5
    s_add_u32 s54, s54, 24
    s_lshl_b32 s54, s54, 13
    s_add_u32 s55, s55, s54
    s_lshl_b32 s54, s49, 2
    v_mov_b32 v9, s54
    v_mov_b32 v13, s55
    ds_write_b32 v9, v13 offset:11264
    s_add_u32 s49, s49, 1
    s_add_u32 s47, s47, 1
    s_cmp_lt_u32 s49, 120
    s_cbranch_scc1 L_dsp
L_dsp_end:
    s_lshl_b32 s54, s49, 2
    v_mov_b32 v9, s54
    v_mov_b32 v13, 0xffffffff
    ds_write_b32 v9, v13 offset:11264
    v_mov_b32 v13, 1
    ds_write_b32 v0, v13 offset:10504
    s_waitcnt lgkmcnt(0) vmcnt(0)
    s_endpgm
L_end:
    s_endpgm
.section .rodata,"a"
.p2align 6
.amdhsa_kernel recurrent_scan__gqa_block_cached__geglu_ffn__decode_kernel
  .amdhsa_next_free_vgpr 256
  .amdhsa_next_free_sgpr 102
  .amdhsa_accum_offset 256
  .amdhsa_group_segment_fixed_size 0
  .amdhsa_kernarg_size 96
  .amdhsa_user_sgpr_count 2
  .amdhsa_user_sgpr_kernarg_segment_ptr 1
  .amdhsa_system_sgpr_workgroup_id_x 1
  .amdhsa_float_denorm_mode_32 3
.end_amdhsa_kernel
```
